```python
import torch

def _softmax(x, axis=-1):
    return torch.softmax(x, dim=axis)
def _gelu(x):
    return torch.nn.functional.gelu(x, approximate="tanh")
def _silu(x):
    return torch.nn.functional.silu(x)
def _sigmoid(x):
    return torch.sigmoid(x)
def _layernorm(x, axis=-1, eps=1e-5):
    m = x.mean(dim=axis, keepdim=True)
    v = x.var(dim=axis, keepdim=True, unbiased=False)
    return (x - m) / torch.sqrt(v + eps)
def _scatter_add(tgt, idx, src, axis=0):
    return tgt.clone().index_add_(axis, idx, src)
def _segment_sum(src, seg, n):
    out = torch.zeros((n,) + src.shape[1:], dtype=src.dtype)
    return out.index_add_(0, seg, src)
def _pad(x, pw):
    flat = tuple(v for pair in reversed(pw) for v in pair)
    return torch.nn.functional.pad(x, flat)

kernel_name = 'interleave_layers__sliding_block_cached__mixer_token_mlp__decode'

def setup_inputs():

    _w = (lambda a: (lambda t: t.to(torch.bfloat16) if t.is_floating_point() else t)(torch.as_tensor(a)))
    def _A_setup():
        B, Sq, D = 4, 1, 512
        Hq, Hkv, Sk, Dh = 32, 8, 4096, 128
        assert Hq % Hkv == 0, (Hq, Hkv)
        return {
            "x": _w((lambda *s: torch.randn(*s, dtype=torch.bfloat16) * 0.05)(B, Sq, D)),
            "k_cache": _w((lambda *s: torch.randn(*s, dtype=torch.bfloat16) * 0.8)(B, Hkv, Sk, Dh)),
            "v_cache": _w((lambda *s: torch.randn(*s, dtype=torch.bfloat16) * 1.6)(B, Hkv, Sk, Dh)),
            "wq": _w((lambda *s: torch.randn(*s, dtype=torch.bfloat16) * 0.8)(D, Hq * Dh) * (D ** -0.5)),
            "wo": _w((lambda *s: torch.randn(*s, dtype=torch.bfloat16) * 1.6)(Hq * Dh, D) * ((Hq * Dh) ** -0.5)),
        }
    _A_in = _A_setup()

    def _B_setup():
        B, S, D, F = 4, 1, 512, 1792
        return {
            "x": _w((lambda *s: torch.randn(*s, dtype=torch.bfloat16) * 0.05)(B, S, D)),
            "w1": _w((lambda *s: torch.randn(*s, dtype=torch.bfloat16) * 1.6)(S, F) * (S ** -0.5)),
            "b1": _w((lambda *s: torch.randn(*s, dtype=torch.bfloat16) * 1.6)(F) * 0.02),
            "w2": _w((lambda *s: torch.randn(*s, dtype=torch.bfloat16) * 0.2)(F, S) * (F ** -0.5)),
            "b2": _w((lambda *s: torch.randn(*s, dtype=torch.bfloat16) * 0.2)(S) * 0.02),
        }
    _B_in = _B_setup()

    return {
        "A_x": _A_in["x"],
        "A_k_cache": _A_in["k_cache"],
        "A_v_cache": _A_in["v_cache"],
        "A_wq": _A_in["wq"],
        "A_wo": _A_in["wo"],
        "B_x": _B_in["x"],
        "B_w1": _B_in["w1"],
        "B_b1": _B_in["b1"],
        "B_w2": _B_in["w2"],
        "B_b2": _B_in["b2"],
    }

def reference(A_x, A_k_cache, A_v_cache, A_wq, A_wo, B_x, B_w1, B_b1, B_w2, B_b2):
    def _A_ref(x, k_cache, v_cache, wq, wo):
        B, Sq, D = x.shape
        Hq, Dh = 32, 128
        Hkv, Sk = k_cache.shape[1], k_cache.shape[2]
        W = min(4096, max(256, Sk // 4))
        rep = Hq // Hkv
        q = (lambda x, *d: x.permute(*d))((x @ wq).reshape(B, Sq, Hq, Dh), 0, 2, 1, 3)
        k = (lambda x, n, axis: torch.repeat_interleave(x, n, dim=axis))(k_cache[:, :, Sk - W:, :], rep, axis=1)
        v = (lambda x, n, axis: torch.repeat_interleave(x, n, dim=axis))(v_cache[:, :, Sk - W:, :], rep, axis=1)
        scores = torch.einsum("bhqd,bhkd->bhqk", q, k) * (Dh ** -0.5)
        p = _softmax(scores, axis=-1)
        o = torch.einsum("bhqk,bhkd->bhqd", p, v)
        return (lambda x, *d: x.permute(*d))(o, 0, 2, 1, 3).reshape(B, Sq, Hq * Dh) @ wo

    def _B_ref(x, w1, b1, w2, b2):
        B, S, D = x.shape
        h = _layernorm(x, axis=-1)
        u = torch.einsum("bsd,sf->bdf", h, w1) + b1
        u = _gelu(u)
        y = torch.einsum("bdf,fs->bds", u, w2) + b2
        return (lambda x, *d: x.permute(*d))(y, 0, 2, 1)

    x = A_x
    x = x + _A_ref(_layernorm(x, axis=-1), A_k_cache, A_v_cache, A_wq, A_wo)
    x = x + _B_ref(_layernorm(x, axis=-1), B_w1, B_b1, B_w2, B_b2)
    x = x + _A_ref(_layernorm(x, axis=-1), A_k_cache, A_v_cache, A_wq, A_wo)
    x = x + _B_ref(_layernorm(x, axis=-1), B_w1, B_b1, B_w2, B_b2)
    return x
```

```asm
; @launch grid=(256,1,1) block=(512,1,1) lds=102720
.amdgcn_target "amdgcn-amd-amdhsa--gfx950"
.text
.globl interleave_layers__sliding_block_cached__mixer_token_mlp__decode_kernel
.p2align 8
.type interleave_layers__sliding_block_cached__mixer_token_mlp__decode_kernel,@function
interleave_layers__sliding_block_cached__mixer_token_mlp__decode_kernel:
    s_lshr_b32 s10, s2, 8
    s_cbranch_scc1 Lend
    s_load_dwordx2 s[52:53], s[0:1], 24
    s_load_dwordx4 s[12:15], s[0:1], 0
    v_readfirstlane_b32 s3, v0
    s_getpc_b64 s[10:11]
Lpc0:
    s_lshr_b32 s96, s2, 3
    s_lshl_b32 s16, s96, 9
    s_cmp_lg_u32 s3, 0
    s_cbranch_scc1 Lnopf
    v_and_b32 v19, 3, v0
    v_lshl_add_u32 v19, v19, 7, s16
    global_load_dword v192, v19, s[10:11]
Lnopf:
    s_and_b32 s4, s2, 7
    s_lshr_b32 s5, s2, 6
    s_and_b32 s6, s96, 7
    s_lshl_b32 s55, 1, 17
    s_bitcmp1_b32 s3, 8
    s_cbranch_scc1 Lhelp0
    v_lshrrev_b32 v23, 3, v0
    v_and_b32 v22, 7, v0
    v_and_b32 v24, 2, v23
    v_lshrrev_b32 v25, 1, v23
    v_and_or_b32 v24, v25, 4, v24
    v_xor_b32 v22, v22, v24
    v_lshlrev_b32 v22, 4, v22
    v_lshl_add_u32 v22, v23, 13, v22
    s_lshl_b32 s17, s5, 20
    s_lshl_b32 s10, s4, 10
    s_add_u32 s17, s17, s10
    s_lshl_b32 s10, s6, 7
    s_add_u32 s17, s17, s10
    s_lshl_b32 s54, 1, 22
    s_lshl_b32 s11, 1, 18
    s_lshl_b32 s18, s3, 4
    s_add_u32 m0, s18, 12288
    v_lshlrev_b32 v21, 4, v0
    s_waitcnt lgkmcnt(0)
    global_load_dwordx4 v[248:251], v21, s[12:13]
    buffer_load_dwordx4 v22, s[52:55], s17 offen nt lds
    s_addk_i32 m0, 0x1000
    s_add_u32 s17, s17, s11
    buffer_load_dwordx4 v22, s[52:55], s17 offen nt lds
    s_addk_i32 m0, 0x1000
    s_add_u32 s17, s17, s11
    buffer_load_dwordx4 v22, s[52:55], s17 offen nt lds
    s_addk_i32 m0, 0x1000
    s_add_u32 s17, s17, s11
    buffer_load_dwordx4 v22, s[52:55], s17 offen nt lds
    v_and_b32 v1, 63, v0
    v_mov_b32 v29, 102656
    v_lshlrev_b32 v2, 4, v1
    v_lshrrev_b32 v16, 4, v1
    v_and_b32 v17, 15, v1
    v_mov_b32 v20, 0
    s_lshl_b32 s46, 1, 25
    s_mov_b32 s47, s55
    s_mov_b64 s[44:45], s[14:15]
    v_xor_b32 v18, v17, v16
    v_lshlrev_b32 v18, 4, v18
    v_lshl_add_u32 v224, v16, 8, v18
    s_lshl_b32 s86, s6, 10
    s_bfe_u32 s11, s86, 0x2000a
    s_lshl_b32 s11, s11, 6
    s_add_u32 s16, s11, 64
    s_and_b32 s16, s16, 0xc0
    v_xor_b32 v225, s16, v224
    s_add_u32 s16, s11, 128
    s_and_b32 s16, s16, 0xc0
    v_xor_b32 v226, s16, v224
    s_add_u32 s16, s11, 192
    s_and_b32 s16, s16, 0xc0
    v_xor_b32 v227, s16, v224
    v_xor_b32 v224, s11, v224
    s_lshl_b32 s84, s5, 23
    s_lshl_b32 s10, s4, 20
    s_add_u32 s84, s84, s10
    s_lshl_b32 s10, s6, 15
    s_add_u32 s84, s84, s10
    s_lshl_b32 s10, s3, 7
    s_add_u32 s84, s84, s10
    s_add_u32 s84, s84, 0x000c0000
    s_add_u32 s85, s10, 28672
    s_add_u32 m0, s85, s86
    s_add_u32 s16, s84, s86
    buffer_load_dwordx4 v224, s[44:47], s16 offen nt lds
    s_addk_i32 s86, 1024
    s_and_b32 s86, s86, 0x1fff
    s_add_u32 m0, s85, s86
    s_add_u32 s16, s84, s86
    buffer_load_dwordx4 v225, s[44:47], s16 offen nt lds
    s_addk_i32 s86, 1024
    s_and_b32 s86, s86, 0x1fff
    s_add_u32 m0, s85, s86
    s_add_u32 s16, s84, s86
    buffer_load_dwordx4 v226, s[44:47], s16 offen nt lds
    s_addk_i32 s86, 1024
    s_and_b32 s86, s86, 0x1fff
    s_add_u32 s87, s10, 61440
    s_lshr_b32 s3, s3, 6
    s_branch Lmain
Lhelp0:
    s_load_dwordx2 s[72:73], s[0:1], 48
    s_load_dwordx2 s[76:77], s[0:1], 56
    s_load_dwordx2 s[80:81], s[0:1], 64
    s_load_dwordx2 s[60:61], s[0:1], 96
    s_load_dwordx2 s[40:41], s[0:1], 72
    v_and_b32 v1, 63, v0
    v_mov_b32 v29, 102656
    v_lshlrev_b32 v2, 4, v1
    v_lshrrev_b32 v16, 4, v1
    v_and_b32 v17, 15, v1
    v_mov_b32 v20, 0
    v_mov_b32 v21, 0
    ds_write_b64 v29, v[20:21] offset:0
    ds_write_b64 v29, v[20:21] offset:8
    ds_write_b64 v29, v[20:21] offset:16
    ds_write_b64 v29, v[20:21] offset:24
    ds_write_b32 v29, v20 offset:44
    ds_write_b32 v29, v20 offset:60
    s_bfe_u32 s3, s3, 0x20006
    s_mov_b32 s62, 0x00400000
    s_mov_b32 s63, 0x00020000
    s_mov_b32 s74, 0x00000e00
    s_mov_b32 s75, 0x00020000
    s_mov_b32 s78, 0x00000e00
    s_mov_b32 s79, 0x00020000
    s_mov_b32 s82, 0x00000e00
    s_mov_b32 s83, 0x00020000
    v_mov_b32 v232, -1
    v_mov_b32 v233, -1
    v_mov_b32 v234, -1
    v_mov_b32 v235, -1
    s_waitcnt lgkmcnt(0)
    s_lshl_b32 s13, s3, 10
    s_mul_i32 s15, s96, 1040
    s_lshl_b32 s7, s4, 17
    s_add_u32 s15, s15, s7
    s_add_u32 s14, s15, 1024
    s_lshl_b32 s11, s96, 7
    v_mov_b32 v19, s11
    s_cmp_ge_u32 s3, 2
    s_cbranch_scc1 Lhc_pf
    s_cmp_eq_u32 s3, 0
    s_cselect_b32 s15, s15, s14
    s_cselect_b64 exec, -1, 1
    buffer_store_dwordx4 v[232:235], v2, s[60:63], s15 offen sc1
    s_branch Lhc_skip
Lhc_pf:
Lhc_skip:
    s_mov_b64 exec, -1
    s_mov_b32 m0, s13
    s_nop 0
    buffer_load_dwordx4 v2, s[72:75], s13 offen lds
    s_addk_i32 m0, 0x1000
    s_nop 0
    buffer_load_dwordx4 v2, s[76:79], s13 offen lds
    s_addk_i32 m0, 0x1000
    s_nop 0
    buffer_load_dwordx4 v2, s[80:83], s13 offen lds
    s_load_dword s36, s[40:41], 0
    s_barrier
    s_lshl_b32 s84, s2, 2
    s_add_u32 s84, s84, s3
    s_lshr_b32 s86, s84, 1
    s_add_u32 s86, s86, 14080
    s_lshl_b32 s86, s86, 16
    s_lshl_b32 s10, s84, 31
    s_or_b32 s86, s86, s10
    s_mul_i32 s84, s84, 2
    s_lshl_b32 s85, s84, 3
    s_add_u32 s85, s85, 4096
    s_add_u32 s84, s84, 14592
    s_lshl_b32 s84, s84, 16
    v_lshlrev_b32 v27, 2, v1
    v_add_u32 v27, s85, v27
    s_mov_b32 s85, 0x00140000
    v_mov_b32 v88, 0xc0135761
    v_mov_b32 v89, 0xc0135761
    v_mov_b32 v90, 0xbdd2d3e8
    v_mov_b32 v91, 0xbdd2d3e8
    v_mov_b32 v92, 0x3f800000
    v_mov_b32 v93, 0x3f800000
    v_mov_b32 v94, 0
    s_mov_b32 s25, 0
    s_cmp_lg_u32 s3, 0
    s_cbranch_scc1 Lwm0
    s_call_b64 s[32:33], Lst_k
Lwm0:
    s_cmp_lg_u32 s3, 1
    s_cbranch_scc1 Lwm1
    s_call_b64 s[32:33], Lst_fin
Lwm1:
    s_cmp_lg_u32 s3, 2
    s_cbranch_scc1 Lwm2
    s_call_b64 s[32:33], Lst_out
    s_call_b64 s[32:33], Lst_mq
Lwm2:
    s_cmp_lg_u32 s3, 3
    s_cbranch_scc1 Lwm3
    s_call_b64 s[32:33], Lst_tab
Lwm3:
    v_lshlrev_b32 v26, 3, v1
    s_waitcnt vmcnt(3)
    v_mov_b32 v24, 1
    s_mov_b64 exec, 1
    ds_add_u32 v29, v24 offset:0
    s_mov_b64 exec, -1
    s_waitcnt vmcnt(0)
    v_mov_b32 v24, 1
    s_mov_b64 exec, 1
    ds_add_u32 v29, v24 offset:24
    s_mov_b64 exec, -1
    s_mov_b32 s12, 0x00100000
Ls1:
    ds_read_b32 v24, v29 offset:24
    s_waitcnt lgkmcnt(0)
    v_readfirstlane_b32 s11, v24
    s_cmp_ge_u32 s11, 4
    s_cbranch_scc1 Lt1
    s_sub_u32 s12, s12, 1
    s_cbranch_scc0 Ls1
Lt1:
    ds_read_b128 v[192:195], v2 offset:0
    ds_read_b128 v[196:199], v2 offset:1024
    ds_read_b128 v[200:203], v2 offset:2048
    ds_read_b64 v[204:205], v26 offset:3072
    ds_read_b128 v[206:209], v2 offset:4096
    ds_read_b128 v[210:213], v2 offset:5120
    ds_read_b128 v[214:217], v2 offset:6144
    ds_read_b64 v[218:219], v26 offset:7168
    ds_read_b128 v[220:223], v2 offset:8192
    ds_read_b128 v[224:227], v2 offset:9216
    ds_read_b128 v[228:231], v2 offset:10240
    ds_read_b64 v[232:233], v26 offset:11264
    s_waitcnt lgkmcnt(8)
    v_lshlrev_b32 v32, 16, v192
    v_and_b32 v33, 0xffff0000, v192
    v_lshlrev_b32 v34, 16, v193
    v_and_b32 v35, 0xffff0000, v193
    v_lshlrev_b32 v36, 16, v194
    v_and_b32 v37, 0xffff0000, v194
    v_lshlrev_b32 v38, 16, v195
    v_and_b32 v39, 0xffff0000, v195
    v_lshlrev_b32 v40, 16, v196
    v_and_b32 v41, 0xffff0000, v196
    v_lshlrev_b32 v42, 16, v197
    v_and_b32 v43, 0xffff0000, v197
    v_lshlrev_b32 v44, 16, v198
    v_and_b32 v45, 0xffff0000, v198
    v_lshlrev_b32 v46, 16, v199
    v_and_b32 v47, 0xffff0000, v199
    v_lshlrev_b32 v48, 16, v200
    v_and_b32 v49, 0xffff0000, v200
    v_lshlrev_b32 v50, 16, v201
    v_and_b32 v51, 0xffff0000, v201
    v_lshlrev_b32 v52, 16, v202
    v_and_b32 v53, 0xffff0000, v202
    v_lshlrev_b32 v54, 16, v203
    v_and_b32 v55, 0xffff0000, v203
    v_lshlrev_b32 v56, 16, v204
    v_and_b32 v57, 0xffff0000, v204
    v_lshlrev_b32 v58, 16, v205
    v_and_b32 v59, 0xffff0000, v205
    s_waitcnt lgkmcnt(4)
    v_lshlrev_b32 v60, 16, v206
    v_and_b32 v61, 0xffff0000, v206
    v_lshlrev_b32 v62, 16, v207
    v_and_b32 v63, 0xffff0000, v207
    v_lshlrev_b32 v64, 16, v208
    v_and_b32 v65, 0xffff0000, v208
    v_lshlrev_b32 v66, 16, v209
    v_and_b32 v67, 0xffff0000, v209
    v_lshlrev_b32 v68, 16, v210
    v_and_b32 v69, 0xffff0000, v210
    v_lshlrev_b32 v70, 16, v211
    v_and_b32 v71, 0xffff0000, v211
    v_lshlrev_b32 v72, 16, v212
    v_and_b32 v73, 0xffff0000, v212
    v_lshlrev_b32 v74, 16, v213
    v_and_b32 v75, 0xffff0000, v213
    v_lshlrev_b32 v76, 16, v214
    v_and_b32 v77, 0xffff0000, v214
    v_lshlrev_b32 v78, 16, v215
    v_and_b32 v79, 0xffff0000, v215
    v_lshlrev_b32 v80, 16, v216
    v_and_b32 v81, 0xffff0000, v216
    v_lshlrev_b32 v82, 16, v217
    v_and_b32 v83, 0xffff0000, v217
    v_lshlrev_b32 v84, 16, v218
    v_and_b32 v85, 0xffff0000, v218
    v_lshlrev_b32 v86, 16, v219
    v_and_b32 v87, 0xffff0000, v219
    s_waitcnt lgkmcnt(0)
    v_lshlrev_b32 v112, 16, v220
    v_and_b32 v113, 0xffff0000, v220
    v_lshlrev_b32 v114, 16, v221
    v_and_b32 v115, 0xffff0000, v221
    v_lshlrev_b32 v116, 16, v222
    v_and_b32 v117, 0xffff0000, v222
    v_lshlrev_b32 v118, 16, v223
    v_and_b32 v119, 0xffff0000, v223
    v_lshlrev_b32 v120, 16, v224
    v_and_b32 v121, 0xffff0000, v224
    v_lshlrev_b32 v122, 16, v225
    v_and_b32 v123, 0xffff0000, v225
    v_lshlrev_b32 v124, 16, v226
    v_and_b32 v125, 0xffff0000, v226
    v_lshlrev_b32 v126, 16, v227
    v_and_b32 v127, 0xffff0000, v227
    v_lshlrev_b32 v128, 16, v228
    v_and_b32 v129, 0xffff0000, v228
    v_lshlrev_b32 v130, 16, v229
    v_and_b32 v131, 0xffff0000, v229
    v_lshlrev_b32 v132, 16, v230
    v_and_b32 v133, 0xffff0000, v230
    v_lshlrev_b32 v134, 16, v231
    v_and_b32 v135, 0xffff0000, v231
    v_lshlrev_b32 v136, 16, v232
    v_and_b32 v137, 0xffff0000, v232
    v_lshlrev_b32 v138, 16, v233
    v_and_b32 v139, 0xffff0000, v233
Lhl:
    s_mov_b32 s28, s84
    s_mov_b32 s29, s84
    s_xor_b32 s30, s84, 0x80000000
    s_mov_b32 s31, s30
    v_pk_fma_f32 v[144:145], v[32:33], s[28:29], v[60:61]
    v_pk_fma_f32 v[146:147], v[32:33], s[30:31], v[60:61]
    v_pk_fma_f32 v[148:149], v[34:35], s[28:29], v[62:63]
    v_pk_fma_f32 v[150:151], v[34:35], s[30:31], v[62:63]
    v_pk_mul_f32 v[152:153], v[144:145], v[144:145]
    v_pk_mul_f32 v[154:155], v[146:147], v[146:147]
    v_pk_mul_f32 v[156:157], v[148:149], v[148:149]
    v_pk_mul_f32 v[158:159], v[150:151], v[150:151]
    v_pk_fma_f32 v[152:153], v[152:153], v[90:91], v[88:89]
    v_pk_fma_f32 v[154:155], v[154:155], v[90:91], v[88:89]
    v_pk_fma_f32 v[156:157], v[156:157], v[90:91], v[88:89]
    v_pk_fma_f32 v[158:159], v[158:159], v[90:91], v[88:89]
    v_pk_mul_f32 v[152:153], v[152:153], v[144:145]
    v_pk_mul_f32 v[154:155], v[154:155], v[146:147]
    v_pk_mul_f32 v[156:157], v[156:157], v[148:149]
    v_pk_mul_f32 v[158:159], v[158:159], v[150:151]
    v_exp_f32 v152, v152
    v_exp_f32 v153, v153
    v_exp_f32 v154, v154
    v_exp_f32 v155, v155
    v_exp_f32 v156, v156
    v_exp_f32 v157, v157
    v_exp_f32 v158, v158
    v_exp_f32 v159, v159
    v_pk_mul_f32 v[160:161], v[144:145], v[112:113]
    v_pk_mul_f32 v[162:163], v[146:147], v[112:113]
    v_pk_mul_f32 v[164:165], v[148:149], v[114:115]
    v_pk_mul_f32 v[166:167], v[150:151], v[114:115]
    v_pk_add_f32 v[152:153], v[152:153], v[92:93]
    v_pk_add_f32 v[154:155], v[154:155], v[92:93]
    v_pk_add_f32 v[156:157], v[156:157], v[92:93]
    v_pk_add_f32 v[158:159], v[158:159], v[92:93]
    v_rcp_f32 v152, v152
    v_rcp_f32 v153, v153
    v_rcp_f32 v154, v154
    v_rcp_f32 v155, v155
    v_rcp_f32 v156, v156
    v_rcp_f32 v157, v157
    v_rcp_f32 v158, v158
    v_rcp_f32 v159, v159
    v_pk_mul_f32 v[140:141], v[160:161], v[152:153]
    v_pk_mul_f32 v[142:143], v[162:163], v[154:155]
    v_pk_fma_f32 v[140:141], v[164:165], v[156:157], v[140:141]
    v_pk_fma_f32 v[142:143], v[166:167], v[158:159], v[142:143]
    v_pk_fma_f32 v[144:145], v[36:37], s[28:29], v[64:65]
    v_pk_fma_f32 v[146:147], v[36:37], s[30:31], v[64:65]
    v_pk_fma_f32 v[148:149], v[38:39], s[28:29], v[66:67]
    v_pk_fma_f32 v[150:151], v[38:39], s[30:31], v[66:67]
    v_pk_mul_f32 v[152:153], v[144:145], v[144:145]
    v_pk_mul_f32 v[154:155], v[146:147], v[146:147]
    v_pk_mul_f32 v[156:157], v[148:149], v[148:149]
    v_pk_mul_f32 v[158:159], v[150:151], v[150:151]
    v_pk_fma_f32 v[152:153], v[152:153], v[90:91], v[88:89]
    v_pk_fma_f32 v[154:155], v[154:155], v[90:91], v[88:89]
    v_pk_fma_f32 v[156:157], v[156:157], v[90:91], v[88:89]
    v_pk_fma_f32 v[158:159], v[158:159], v[90:91], v[88:89]
    v_pk_mul_f32 v[152:153], v[152:153], v[144:145]
    v_pk_mul_f32 v[154:155], v[154:155], v[146:147]
    v_pk_mul_f32 v[156:157], v[156:157], v[148:149]
    v_pk_mul_f32 v[158:159], v[158:159], v[150:151]
    v_exp_f32 v152, v152
    v_exp_f32 v153, v153
    v_exp_f32 v154, v154
    v_exp_f32 v155, v155
    v_exp_f32 v156, v156
    v_exp_f32 v157, v157
    v_exp_f32 v158, v158
    v_exp_f32 v159, v159
    v_pk_mul_f32 v[160:161], v[144:145], v[116:117]
    v_pk_mul_f32 v[162:163], v[146:147], v[116:117]
    v_pk_mul_f32 v[164:165], v[148:149], v[118:119]
    v_pk_mul_f32 v[166:167], v[150:151], v[118:119]
    v_pk_add_f32 v[152:153], v[152:153], v[92:93]
    v_pk_add_f32 v[154:155], v[154:155], v[92:93]
    v_pk_add_f32 v[156:157], v[156:157], v[92:93]
    v_pk_add_f32 v[158:159], v[158:159], v[92:93]
    v_rcp_f32 v152, v152
    v_rcp_f32 v153, v153
    v_rcp_f32 v154, v154
    v_rcp_f32 v155, v155
    v_rcp_f32 v156, v156
    v_rcp_f32 v157, v157
    v_rcp_f32 v158, v158
    v_rcp_f32 v159, v159
    v_pk_fma_f32 v[140:141], v[160:161], v[152:153], v[140:141]
    v_pk_fma_f32 v[142:143], v[162:163], v[154:155], v[142:143]
    v_pk_fma_f32 v[140:141], v[164:165], v[156:157], v[140:141]
    v_pk_fma_f32 v[142:143], v[166:167], v[158:159], v[142:143]
    v_pk_fma_f32 v[144:145], v[40:41], s[28:29], v[68:69]
    v_pk_fma_f32 v[146:147], v[40:41], s[30:31], v[68:69]
    v_pk_fma_f32 v[148:149], v[42:43], s[28:29], v[70:71]
    v_pk_fma_f32 v[150:151], v[42:43], s[30:31], v[70:71]
    v_pk_mul_f32 v[152:153], v[144:145], v[144:145]
    v_pk_mul_f32 v[154:155], v[146:147], v[146:147]
    v_pk_mul_f32 v[156:157], v[148:149], v[148:149]
    v_pk_mul_f32 v[158:159], v[150:151], v[150:151]
    v_pk_fma_f32 v[152:153], v[152:153], v[90:91], v[88:89]
    v_pk_fma_f32 v[154:155], v[154:155], v[90:91], v[88:89]
    v_pk_fma_f32 v[156:157], v[156:157], v[90:91], v[88:89]
    v_pk_fma_f32 v[158:159], v[158:159], v[90:91], v[88:89]
    v_pk_mul_f32 v[152:153], v[152:153], v[144:145]
    v_pk_mul_f32 v[154:155], v[154:155], v[146:147]
    v_pk_mul_f32 v[156:157], v[156:157], v[148:149]
    v_pk_mul_f32 v[158:159], v[158:159], v[150:151]
    v_exp_f32 v152, v152
    v_exp_f32 v153, v153
    v_exp_f32 v154, v154
    v_exp_f32 v155, v155
    v_exp_f32 v156, v156
    v_exp_f32 v157, v157
    v_exp_f32 v158, v158
    v_exp_f32 v159, v159
    v_pk_mul_f32 v[160:161], v[144:145], v[120:121]
    v_pk_mul_f32 v[162:163], v[146:147], v[120:121]
    v_pk_mul_f32 v[164:165], v[148:149], v[122:123]
    v_pk_mul_f32 v[166:167], v[150:151], v[122:123]
    v_pk_add_f32 v[152:153], v[152:153], v[92:93]
    v_pk_add_f32 v[154:155], v[154:155], v[92:93]
    v_pk_add_f32 v[156:157], v[156:157], v[92:93]
    v_pk_add_f32 v[158:159], v[158:159], v[92:93]
    v_rcp_f32 v152, v152
    v_rcp_f32 v153, v153
    v_rcp_f32 v154, v154
    v_rcp_f32 v155, v155
    v_rcp_f32 v156, v156
    v_rcp_f32 v157, v157
    v_rcp_f32 v158, v158
    v_rcp_f32 v159, v159
    v_pk_fma_f32 v[140:141], v[160:161], v[152:153], v[140:141]
    v_pk_fma_f32 v[142:143], v[162:163], v[154:155], v[142:143]
    v_pk_fma_f32 v[140:141], v[164:165], v[156:157], v[140:141]
    v_pk_fma_f32 v[142:143], v[166:167], v[158:159], v[142:143]
    v_pk_fma_f32 v[144:145], v[44:45], s[28:29], v[72:73]
    v_pk_fma_f32 v[146:147], v[44:45], s[30:31], v[72:73]
    v_pk_fma_f32 v[148:149], v[46:47], s[28:29], v[74:75]
    v_pk_fma_f32 v[150:151], v[46:47], s[30:31], v[74:75]
    v_pk_mul_f32 v[152:153], v[144:145], v[144:145]
    v_pk_mul_f32 v[154:155], v[146:147], v[146:147]
    v_pk_mul_f32 v[156:157], v[148:149], v[148:149]
    v_pk_mul_f32 v[158:159], v[150:151], v[150:151]
    v_pk_fma_f32 v[152:153], v[152:153], v[90:91], v[88:89]
    v_pk_fma_f32 v[154:155], v[154:155], v[90:91], v[88:89]
    v_pk_fma_f32 v[156:157], v[156:157], v[90:91], v[88:89]
    v_pk_fma_f32 v[158:159], v[158:159], v[90:91], v[88:89]
    v_pk_mul_f32 v[152:153], v[152:153], v[144:145]
    v_pk_mul_f32 v[154:155], v[154:155], v[146:147]
    v_pk_mul_f32 v[156:157], v[156:157], v[148:149]
    v_pk_mul_f32 v[158:159], v[158:159], v[150:151]
    v_exp_f32 v152, v152
    v_exp_f32 v153, v153
    v_exp_f32 v154, v154
    v_exp_f32 v155, v155
    v_exp_f32 v156, v156
    v_exp_f32 v157, v157
    v_exp_f32 v158, v158
    v_exp_f32 v159, v159
    v_pk_mul_f32 v[160:161], v[144:145], v[124:125]
    v_pk_mul_f32 v[162:163], v[146:147], v[124:125]
    v_pk_mul_f32 v[164:165], v[148:149], v[126:127]
    v_pk_mul_f32 v[166:167], v[150:151], v[126:127]
    v_pk_add_f32 v[152:153], v[152:153], v[92:93]
    v_pk_add_f32 v[154:155], v[154:155], v[92:93]
    v_pk_add_f32 v[156:157], v[156:157], v[92:93]
    v_pk_add_f32 v[158:159], v[158:159], v[92:93]
    v_rcp_f32 v152, v152
    v_rcp_f32 v153, v153
    v_rcp_f32 v154, v154
    v_rcp_f32 v155, v155
    v_rcp_f32 v156, v156
    v_rcp_f32 v157, v157
    v_rcp_f32 v158, v158
    v_rcp_f32 v159, v159
    v_pk_fma_f32 v[140:141], v[160:161], v[152:153], v[140:141]
    v_pk_fma_f32 v[142:143], v[162:163], v[154:155], v[142:143]
    v_pk_fma_f32 v[140:141], v[164:165], v[156:157], v[140:141]
    v_pk_fma_f32 v[142:143], v[166:167], v[158:159], v[142:143]
    v_pk_fma_f32 v[144:145], v[48:49], s[28:29], v[76:77]
    v_pk_fma_f32 v[146:147], v[48:49], s[30:31], v[76:77]
    v_pk_fma_f32 v[148:149], v[50:51], s[28:29], v[78:79]
    v_pk_fma_f32 v[150:151], v[50:51], s[30:31], v[78:79]
    v_pk_mul_f32 v[152:153], v[144:145], v[144:145]
    v_pk_mul_f32 v[154:155], v[146:147], v[146:147]
    v_pk_mul_f32 v[156:157], v[148:149], v[148:149]
    v_pk_mul_f32 v[158:159], v[150:151], v[150:151]
    v_pk_fma_f32 v[152:153], v[152:153], v[90:91], v[88:89]
    v_pk_fma_f32 v[154:155], v[154:155], v[90:91], v[88:89]
    v_pk_fma_f32 v[156:157], v[156:157], v[90:91], v[88:89]
    v_pk_fma_f32 v[158:159], v[158:159], v[90:91], v[88:89]
    v_pk_mul_f32 v[152:153], v[152:153], v[144:145]
    v_pk_mul_f32 v[154:155], v[154:155], v[146:147]
    v_pk_mul_f32 v[156:157], v[156:157], v[148:149]
    v_pk_mul_f32 v[158:159], v[158:159], v[150:151]
    v_exp_f32 v152, v152
    v_exp_f32 v153, v153
    v_exp_f32 v154, v154
    v_exp_f32 v155, v155
    v_exp_f32 v156, v156
    v_exp_f32 v157, v157
    v_exp_f32 v158, v158
    v_exp_f32 v159, v159
    v_pk_mul_f32 v[160:161], v[144:145], v[128:129]
    v_pk_mul_f32 v[162:163], v[146:147], v[128:129]
    v_pk_mul_f32 v[164:165], v[148:149], v[130:131]
    v_pk_mul_f32 v[166:167], v[150:151], v[130:131]
    v_pk_add_f32 v[152:153], v[152:153], v[92:93]
    v_pk_add_f32 v[154:155], v[154:155], v[92:93]
    v_pk_add_f32 v[156:157], v[156:157], v[92:93]
    v_pk_add_f32 v[158:159], v[158:159], v[92:93]
    v_rcp_f32 v152, v152
    v_rcp_f32 v153, v153
    v_rcp_f32 v154, v154
    v_rcp_f32 v155, v155
    v_rcp_f32 v156, v156
    v_rcp_f32 v157, v157
    v_rcp_f32 v158, v158
    v_rcp_f32 v159, v159
    v_pk_fma_f32 v[140:141], v[160:161], v[152:153], v[140:141]
    v_pk_fma_f32 v[142:143], v[162:163], v[154:155], v[142:143]
    v_pk_fma_f32 v[140:141], v[164:165], v[156:157], v[140:141]
    v_pk_fma_f32 v[142:143], v[166:167], v[158:159], v[142:143]
    v_pk_fma_f32 v[144:145], v[52:53], s[28:29], v[80:81]
    v_pk_fma_f32 v[146:147], v[52:53], s[30:31], v[80:81]
    v_pk_fma_f32 v[148:149], v[54:55], s[28:29], v[82:83]
    v_pk_fma_f32 v[150:151], v[54:55], s[30:31], v[82:83]
    v_pk_mul_f32 v[152:153], v[144:145], v[144:145]
    v_pk_mul_f32 v[154:155], v[146:147], v[146:147]
    v_pk_mul_f32 v[156:157], v[148:149], v[148:149]
    v_pk_mul_f32 v[158:159], v[150:151], v[150:151]
    v_pk_fma_f32 v[152:153], v[152:153], v[90:91], v[88:89]
    v_pk_fma_f32 v[154:155], v[154:155], v[90:91], v[88:89]
    v_pk_fma_f32 v[156:157], v[156:157], v[90:91], v[88:89]
    v_pk_fma_f32 v[158:159], v[158:159], v[90:91], v[88:89]
    v_pk_mul_f32 v[152:153], v[152:153], v[144:145]
    v_pk_mul_f32 v[154:155], v[154:155], v[146:147]
    v_pk_mul_f32 v[156:157], v[156:157], v[148:149]
    v_pk_mul_f32 v[158:159], v[158:159], v[150:151]
    v_exp_f32 v152, v152
    v_exp_f32 v153, v153
    v_exp_f32 v154, v154
    v_exp_f32 v155, v155
    v_exp_f32 v156, v156
    v_exp_f32 v157, v157
    v_exp_f32 v158, v158
    v_exp_f32 v159, v159
    v_pk_mul_f32 v[160:161], v[144:145], v[132:133]
    v_pk_mul_f32 v[162:163], v[146:147], v[132:133]
    v_pk_mul_f32 v[164:165], v[148:149], v[134:135]
    v_pk_mul_f32 v[166:167], v[150:151], v[134:135]
    v_pk_add_f32 v[152:153], v[152:153], v[92:93]
    v_pk_add_f32 v[154:155], v[154:155], v[92:93]
    v_pk_add_f32 v[156:157], v[156:157], v[92:93]
    v_pk_add_f32 v[158:159], v[158:159], v[92:93]
    v_rcp_f32 v152, v152
    v_rcp_f32 v153, v153
    v_rcp_f32 v154, v154
    v_rcp_f32 v155, v155
    v_rcp_f32 v156, v156
    v_rcp_f32 v157, v157
    v_rcp_f32 v158, v158
    v_rcp_f32 v159, v159
    v_pk_fma_f32 v[140:141], v[160:161], v[152:153], v[140:141]
    v_pk_fma_f32 v[142:143], v[162:163], v[154:155], v[142:143]
    v_pk_fma_f32 v[140:141], v[164:165], v[156:157], v[140:141]
    v_pk_fma_f32 v[142:143], v[166:167], v[158:159], v[142:143]
    v_pk_fma_f32 v[144:145], v[56:57], s[28:29], v[84:85]
    v_pk_fma_f32 v[146:147], v[56:57], s[30:31], v[84:85]
    v_pk_fma_f32 v[148:149], v[58:59], s[28:29], v[86:87]
    v_pk_fma_f32 v[150:151], v[58:59], s[30:31], v[86:87]
    v_pk_mul_f32 v[152:153], v[144:145], v[144:145]
    v_pk_mul_f32 v[154:155], v[146:147], v[146:147]
    v_pk_mul_f32 v[156:157], v[148:149], v[148:149]
    v_pk_mul_f32 v[158:159], v[150:151], v[150:151]
    v_pk_fma_f32 v[152:153], v[152:153], v[90:91], v[88:89]
    v_pk_fma_f32 v[154:155], v[154:155], v[90:91], v[88:89]
    v_pk_fma_f32 v[156:157], v[156:157], v[90:91], v[88:89]
    v_pk_fma_f32 v[158:159], v[158:159], v[90:91], v[88:89]
    v_pk_mul_f32 v[152:153], v[152:153], v[144:145]
    v_pk_mul_f32 v[154:155], v[154:155], v[146:147]
    v_pk_mul_f32 v[156:157], v[156:157], v[148:149]
    v_pk_mul_f32 v[158:159], v[158:159], v[150:151]
    v_exp_f32 v152, v152
    v_exp_f32 v153, v153
    v_exp_f32 v154, v154
    v_exp_f32 v155, v155
    v_exp_f32 v156, v156
    v_exp_f32 v157, v157
    v_exp_f32 v158, v158
    v_exp_f32 v159, v159
    v_pk_mul_f32 v[160:161], v[144:145], v[136:137]
    v_pk_mul_f32 v[162:163], v[146:147], v[136:137]
    v_pk_mul_f32 v[164:165], v[148:149], v[138:139]
    v_pk_mul_f32 v[166:167], v[150:151], v[138:139]
    v_pk_add_f32 v[152:153], v[152:153], v[92:93]
    v_pk_add_f32 v[154:155], v[154:155], v[92:93]
    v_pk_add_f32 v[156:157], v[156:157], v[92:93]
    v_pk_add_f32 v[158:159], v[158:159], v[92:93]
    v_rcp_f32 v152, v152
    v_rcp_f32 v153, v153
    v_rcp_f32 v154, v154
    v_rcp_f32 v155, v155
    v_rcp_f32 v156, v156
    v_rcp_f32 v157, v157
    v_rcp_f32 v158, v158
    v_rcp_f32 v159, v159
    v_pk_fma_f32 v[140:141], v[160:161], v[152:153], v[140:141]
    v_pk_fma_f32 v[142:143], v[162:163], v[154:155], v[142:143]
    v_pk_fma_f32 v[140:141], v[164:165], v[156:157], v[140:141]
    v_pk_fma_f32 v[142:143], v[166:167], v[158:159], v[142:143]
    v_add_f32 v140, v140, v141
    v_add_f32 v142, v142, v143
    s_lshl_b32 m0, s25, 1
    s_add_u32 s84, s84, 0x10000
    v_add_f32_dpp v140, v140, v140 row_ror:8 row_mask:0xf bank_mask:0xf
    v_add_f32_dpp v142, v142, v142 row_ror:8 row_mask:0xf bank_mask:0xf
    s_nop 0
    v_add_f32_dpp v140, v140, v140 row_ror:4 row_mask:0xf bank_mask:0xf
    v_add_f32_dpp v142, v142, v142 row_ror:4 row_mask:0xf bank_mask:0xf
    s_nop 0
    v_add_f32_dpp v140, v140, v140 row_ror:2 row_mask:0xf bank_mask:0xf
    v_add_f32_dpp v142, v142, v142 row_ror:2 row_mask:0xf bank_mask:0xf
    s_nop 0
    v_add_f32_dpp v140, v140, v140 row_ror:1 row_mask:0xf bank_mask:0xf
    v_add_f32_dpp v142, v142, v142 row_ror:1 row_mask:0xf bank_mask:0xf
    s_nop 0
    v_add_f32_dpp v140, v140, v140 row_bcast:15 row_mask:0xa bank_mask:0xf
    v_add_f32_dpp v142, v142, v142 row_bcast:15 row_mask:0xa bank_mask:0xf
    s_nop 0
    v_add_f32_dpp v140, v140, v140 row_bcast:31 row_mask:0xc bank_mask:0xf
    v_add_f32_dpp v142, v142, v142 row_bcast:31 row_mask:0xc bank_mask:0xf
    s_nop 0
    v_readlane_b32 s26, v140, 63
    v_readlane_b32 s27, v142, 63
    s_add_u32 s25, s25, 1
    s_nop 0
    v_writelane_b32 v94, s26, m0
    s_add_u32 m0, m0, 1
    s_cmp_lg_u32 s25, 2
    v_writelane_b32 v94, s27, m0
    s_cbranch_scc1 Lhl
    s_waitcnt lgkmcnt(0)
    s_lshl_b32 s36, s36, 16
    s_mov_b32 s12, 0x00100000
Ls2:
    ds_read_b32 v24, v29 offset:8
    s_waitcnt lgkmcnt(0)
    v_readfirstlane_b32 s11, v24
    s_cmp_ge_u32 s11, 4
    s_cbranch_scc1 Lt2
    s_sub_u32 s12, s12, 1
    s_cbranch_scc0 Ls2
Lt2:
    v_cvt_pk_bf16_f32 v94, v94, v94
    v_and_b32 v94, 0xffff0000, v94
    v_add_f32 v94, s36, v94
    v_cvt_pk_bf16_f32 v94, v94, v94
    v_and_b32 v95, 0xffff0000, v94
    s_mov_b64 exec, 15
    buffer_store_dword v95, v27, s[60:63], s85 offen sc1
    s_mov_b64 exec, -1
    s_mov_b32 s28, s86
    s_mov_b32 s29, s86
    v_pk_fma_f32 v[144:145], v[32:33], s[28:29], v[60:61]
    v_pk_fma_f32 v[146:147], v[34:35], s[28:29], v[62:63]
    v_pk_fma_f32 v[148:149], v[36:37], s[28:29], v[64:65]
    v_pk_fma_f32 v[150:151], v[38:39], s[28:29], v[66:67]
    v_pk_mul_f32 v[152:153], v[144:145], v[144:145]
    v_pk_mul_f32 v[154:155], v[146:147], v[146:147]
    v_pk_mul_f32 v[156:157], v[148:149], v[148:149]
    v_pk_mul_f32 v[158:159], v[150:151], v[150:151]
    v_pk_fma_f32 v[152:153], v[152:153], v[90:91], v[88:89]
    v_pk_fma_f32 v[154:155], v[154:155], v[90:91], v[88:89]
    v_pk_fma_f32 v[156:157], v[156:157], v[90:91], v[88:89]
    v_pk_fma_f32 v[158:159], v[158:159], v[90:91], v[88:89]
    v_pk_mul_f32 v[152:153], v[152:153], v[144:145]
    v_pk_mul_f32 v[154:155], v[154:155], v[146:147]
    v_pk_mul_f32 v[156:157], v[156:157], v[148:149]
    v_pk_mul_f32 v[158:159], v[158:159], v[150:151]
    v_exp_f32 v152, v152
    v_exp_f32 v153, v153
    v_exp_f32 v154, v154
    v_exp_f32 v155, v155
    v_exp_f32 v156, v156
    v_exp_f32 v157, v157
    v_exp_f32 v158, v158
    v_exp_f32 v159, v159
    v_pk_mul_f32 v[160:161], v[144:145], v[112:113]
    v_pk_mul_f32 v[162:163], v[146:147], v[114:115]
    v_pk_mul_f32 v[164:165], v[148:149], v[116:117]
    v_pk_mul_f32 v[166:167], v[150:151], v[118:119]
    v_pk_add_f32 v[152:153], v[152:153], v[92:93]
    v_pk_add_f32 v[154:155], v[154:155], v[92:93]
    v_pk_add_f32 v[156:157], v[156:157], v[92:93]
    v_pk_add_f32 v[158:159], v[158:159], v[92:93]
    v_rcp_f32 v152, v152
    v_rcp_f32 v153, v153
    v_rcp_f32 v154, v154
    v_rcp_f32 v155, v155
    v_rcp_f32 v156, v156
    v_rcp_f32 v157, v157
    v_rcp_f32 v158, v158
    v_rcp_f32 v159, v159
    v_pk_mul_f32 v[140:141], v[160:161], v[152:153]
    v_pk_mul_f32 v[142:143], v[162:163], v[154:155]
    v_pk_fma_f32 v[140:141], v[164:165], v[156:157], v[140:141]
    v_pk_fma_f32 v[142:143], v[166:167], v[158:159], v[142:143]
    v_pk_fma_f32 v[144:145], v[40:41], s[28:29], v[68:69]
    v_pk_fma_f32 v[146:147], v[42:43], s[28:29], v[70:71]
    v_pk_fma_f32 v[148:149], v[44:45], s[28:29], v[72:73]
    v_pk_fma_f32 v[150:151], v[46:47], s[28:29], v[74:75]
    v_pk_mul_f32 v[152:153], v[144:145], v[144:145]
    v_pk_mul_f32 v[154:155], v[146:147], v[146:147]
    v_pk_mul_f32 v[156:157], v[148:149], v[148:149]
    v_pk_mul_f32 v[158:159], v[150:151], v[150:151]
    v_pk_fma_f32 v[152:153], v[152:153], v[90:91], v[88:89]
    v_pk_fma_f32 v[154:155], v[154:155], v[90:91], v[88:89]
    v_pk_fma_f32 v[156:157], v[156:157], v[90:91], v[88:89]
    v_pk_fma_f32 v[158:159], v[158:159], v[90:91], v[88:89]
    v_pk_mul_f32 v[152:153], v[152:153], v[144:145]
    v_pk_mul_f32 v[154:155], v[154:155], v[146:147]
    v_pk_mul_f32 v[156:157], v[156:157], v[148:149]
    v_pk_mul_f32 v[158:159], v[158:159], v[150:151]
    v_exp_f32 v152, v152
    v_exp_f32 v153, v153
    v_exp_f32 v154, v154
    v_exp_f32 v155, v155
    v_exp_f32 v156, v156
    v_exp_f32 v157, v157
    v_exp_f32 v158, v158
    v_exp_f32 v159, v159
    v_pk_mul_f32 v[160:161], v[144:145], v[120:121]
    v_pk_mul_f32 v[162:163], v[146:147], v[122:123]
    v_pk_mul_f32 v[164:165], v[148:149], v[124:125]
    v_pk_mul_f32 v[166:167], v[150:151], v[126:127]
    v_pk_add_f32 v[152:153], v[152:153], v[92:93]
    v_pk_add_f32 v[154:155], v[154:155], v[92:93]
    v_pk_add_f32 v[156:157], v[156:157], v[92:93]
    v_pk_add_f32 v[158:159], v[158:159], v[92:93]
    v_rcp_f32 v152, v152
    v_rcp_f32 v153, v153
    v_rcp_f32 v154, v154
    v_rcp_f32 v155, v155
    v_rcp_f32 v156, v156
    v_rcp_f32 v157, v157
    v_rcp_f32 v158, v158
    v_rcp_f32 v159, v159
    v_pk_fma_f32 v[140:141], v[160:161], v[152:153], v[140:141]
    v_pk_fma_f32 v[142:143], v[162:163], v[154:155], v[142:143]
    v_pk_fma_f32 v[140:141], v[164:165], v[156:157], v[140:141]
    v_pk_fma_f32 v[142:143], v[166:167], v[158:159], v[142:143]
    v_pk_fma_f32 v[144:145], v[48:49], s[28:29], v[76:77]
    v_pk_fma_f32 v[146:147], v[50:51], s[28:29], v[78:79]
    v_pk_fma_f32 v[148:149], v[52:53], s[28:29], v[80:81]
    v_pk_mul_f32 v[152:153], v[144:145], v[144:145]
    v_pk_mul_f32 v[154:155], v[146:147], v[146:147]
    v_pk_mul_f32 v[156:157], v[148:149], v[148:149]
    v_pk_fma_f32 v[152:153], v[152:153], v[90:91], v[88:89]
    v_pk_fma_f32 v[154:155], v[154:155], v[90:91], v[88:89]
    v_pk_fma_f32 v[156:157], v[156:157], v[90:91], v[88:89]
    v_pk_mul_f32 v[152:153], v[152:153], v[144:145]
    v_pk_mul_f32 v[154:155], v[154:155], v[146:147]
    v_pk_mul_f32 v[156:157], v[156:157], v[148:149]
    v_exp_f32 v152, v152
    v_exp_f32 v153, v153
    v_exp_f32 v154, v154
    v_exp_f32 v155, v155
    v_exp_f32 v156, v156
    v_exp_f32 v157, v157
    v_pk_mul_f32 v[160:161], v[144:145], v[128:129]
    v_pk_mul_f32 v[162:163], v[146:147], v[130:131]
    v_pk_mul_f32 v[164:165], v[148:149], v[132:133]
    v_pk_add_f32 v[152:153], v[152:153], v[92:93]
    v_pk_add_f32 v[154:155], v[154:155], v[92:93]
    v_pk_add_f32 v[156:157], v[156:157], v[92:93]
    v_rcp_f32 v152, v152
    v_rcp_f32 v153, v153
    v_rcp_f32 v154, v154
    v_rcp_f32 v155, v155
    v_rcp_f32 v156, v156
    v_rcp_f32 v157, v157
    v_pk_fma_f32 v[140:141], v[160:161], v[152:153], v[140:141]
    v_pk_fma_f32 v[142:143], v[162:163], v[154:155], v[142:143]
    v_pk_fma_f32 v[140:141], v[164:165], v[156:157], v[140:141]
    v_pk_fma_f32 v[144:145], v[54:55], s[28:29], v[82:83]
    v_pk_fma_f32 v[146:147], v[56:57], s[28:29], v[84:85]
    v_pk_fma_f32 v[148:149], v[58:59], s[28:29], v[86:87]
    v_pk_mul_f32 v[152:153], v[144:145], v[144:145]
    v_pk_mul_f32 v[154:155], v[146:147], v[146:147]
    v_pk_mul_f32 v[156:157], v[148:149], v[148:149]
    v_pk_fma_f32 v[152:153], v[152:153], v[90:91], v[88:89]
    v_pk_fma_f32 v[154:155], v[154:155], v[90:91], v[88:89]
    v_pk_fma_f32 v[156:157], v[156:157], v[90:91], v[88:89]
    v_pk_mul_f32 v[152:153], v[152:153], v[144:145]
    v_pk_mul_f32 v[154:155], v[154:155], v[146:147]
    v_pk_mul_f32 v[156:157], v[156:157], v[148:149]
    v_exp_f32 v152, v152
    v_exp_f32 v153, v153
    v_exp_f32 v154, v154
    v_exp_f32 v155, v155
    v_exp_f32 v156, v156
    v_exp_f32 v157, v157
    v_pk_mul_f32 v[160:161], v[144:145], v[134:135]
    v_pk_mul_f32 v[162:163], v[146:147], v[136:137]
    v_pk_mul_f32 v[164:165], v[148:149], v[138:139]
    v_pk_add_f32 v[152:153], v[152:153], v[92:93]
    v_pk_add_f32 v[154:155], v[154:155], v[92:93]
    v_pk_add_f32 v[156:157], v[156:157], v[92:93]
    v_rcp_f32 v152, v152
    v_rcp_f32 v153, v153
    v_rcp_f32 v154, v154
    v_rcp_f32 v155, v155
    v_rcp_f32 v156, v156
    v_rcp_f32 v157, v157
    v_pk_fma_f32 v[142:143], v[160:161], v[152:153], v[142:143]
    v_pk_fma_f32 v[140:141], v[162:163], v[154:155], v[140:141]
    v_pk_fma_f32 v[142:143], v[164:165], v[156:157], v[142:143]
    v_add_f32 v140, v140, v141
    v_add_f32 v142, v142, v143
    v_add_f32 v140, v140, v142
    s_nop 1
    v_add_f32_dpp v140, v140, v140 row_ror:8 row_mask:0xf bank_mask:0xf
    v_add_f32_dpp v142, v142, v142 row_ror:8 row_mask:0xf bank_mask:0xf
    s_nop 0
    v_add_f32_dpp v140, v140, v140 row_ror:4 row_mask:0xf bank_mask:0xf
    v_add_f32_dpp v142, v142, v142 row_ror:4 row_mask:0xf bank_mask:0xf
    s_nop 0
    v_add_f32_dpp v140, v140, v140 row_ror:2 row_mask:0xf bank_mask:0xf
    v_add_f32_dpp v142, v142, v142 row_ror:2 row_mask:0xf bank_mask:0xf
    s_nop 0
    v_add_f32_dpp v140, v140, v140 row_ror:1 row_mask:0xf bank_mask:0xf
    v_add_f32_dpp v142, v142, v142 row_ror:1 row_mask:0xf bank_mask:0xf
    s_nop 0
    v_add_f32_dpp v140, v140, v140 row_bcast:15 row_mask:0xa bank_mask:0xf
    v_add_f32_dpp v142, v142, v142 row_bcast:15 row_mask:0xa bank_mask:0xf
    s_nop 0
    v_add_f32_dpp v140, v140, v140 row_bcast:31 row_mask:0xc bank_mask:0xf
    v_add_f32_dpp v142, v142, v142 row_bcast:31 row_mask:0xc bank_mask:0xf
    s_nop 0
    v_readlane_b32 s26, v140, 63
    v_readlane_b32 s27, v142, 63
    s_nop 1
    v_mov_b32 v94, s26
    v_cvt_pk_bf16_f32 v94, v94, v94
    v_and_b32 v94, 0xffff0000, v94
    v_add_f32 v94, s36, v94
    v_cvt_pk_bf16_f32 v94, v94, v94
    v_and_b32 v94, 0xffff0000, v94
    s_lshl_b32 s10, s3, 2
    v_add_u32 v16, s10, v29
    v_mov_b32 v17, 1
    s_mov_b64 exec, 1
    ds_write_b32 v16, v94 offset:32
    s_waitcnt lgkmcnt(0)
    ds_add_rtn_u32 v18, v29, v17 offset:28
    s_waitcnt lgkmcnt(0)
    v_readfirstlane_b32 s10, v18
    s_cmp_lg_u32 s10, 3
    s_cbranch_scc1 Lhx_end
    ds_read_b128 v[20:23], v29 offset:32
    s_lshl_b32 s10, s2, 4
    v_mov_b32 v16, s10
    s_waitcnt lgkmcnt(0)
    buffer_store_dwordx4 v[20:23], v16, s[60:63], s85 offen sc1
Lhx_end:
    s_mov_b64 exec, -1
    s_barrier
    s_barrier
    s_endpgm
Lmain:
    s_load_dwordx2 s[60:61], s[0:1], 96
    s_load_dwordx2 s[48:49], s[0:1], 16
    s_load_dwordx2 s[56:57], s[0:1], 32
    s_load_dwordx2 s[68:69], s[0:1], 80
    s_load_dwordx2 s[64:65], s[0:1], 0
    s_load_dwordx2 s[40:41], s[0:1], 72
    s_load_dwordx2 s[72:73], s[0:1], 48
    s_load_dwordx2 s[76:77], s[0:1], 56
    s_load_dwordx2 s[80:81], s[0:1], 64
    s_mov_b32 s62, 0x00400000
    s_mov_b32 s63, 0x00020000
    s_mov_b32 s74, 0x00000e00
    s_mov_b32 s75, 0x00020000
    s_mov_b32 s78, 0x00000e00
    s_mov_b32 s79, 0x00020000
    s_mov_b32 s82, 0x00000e00
    s_mov_b32 s83, 0x00020000
    s_barrier
    s_add_u32 m0, s85, s86
    s_add_u32 s16, s84, s86
    buffer_load_dwordx4 v227, s[44:47], s16 offen nt lds
    s_addk_i32 s86, 1024
    s_and_b32 s86, s86, 0x1fff
    v_mov_b32 v184, -1
    v_mov_b32 v185, -1
    v_mov_b32 v186, -1
    v_mov_b32 v187, -1
    s_lshl_b32 s7, s4, 17
    s_mov_b32 s11, s96
    s_waitcnt lgkmcnt(0)
    s_load_dword s39, s[60:61], 0x00017f00
    s_mov_b32 s50, 0x02000000
    s_mov_b32 s51, 0x00020000
    s_mov_b32 s66, 0x00001000
    s_mov_b32 s67, 0x00020000
    s_mov_b32 s58, 0x00400000
    s_mov_b32 s59, 0x00020000
    s_mov_b32 s70, 0x00001000
    s_mov_b32 s71, 0x00020000
    v_lshlrev_b32 v18, 1, v16
    v_xor_b32 v18, v17, v18
    v_lshlrev_b32 v18, 4, v18
    v_lshl_add_u32 v228, v16, 8, v18
    s_and_b32 s10, s6, 1
    s_lshl_b32 s10, s10, 7
    v_xor_b32 v228, s10, v228
    v_xor_b32 v229, 128, v228
    s_lshr_b32 s11, s2, 3
    s_mul_i32 s11, s11, 1680
    s_lshl_b32 s10, s3, 10
    s_add_u32 s11, s11, s10
    s_add_u32 s11, s11, s7
    s_add_u32 s11, s11, 33792
    s_lshl_b32 s10, s2, 10
    s_add_u32 s10, s10, 0x00100000
    s_cmp_ge_u32 s3, 2
    s_cselect_b32 s11, s10, s11
    s_bfm_b64 s[28:29], 41, 0
    s_cmp_eq_u32 s3, 1
    s_cselect_b64 s[28:29], s[28:29], -1
    v_mov_b32 v19, v2
    s_cmp_lg_u32 s3, 3
    s_cbranch_scc1 Lm_c3
    s_mul_i32 s10, s2, 64
    s_add_u32 s10, s10, 4096
    v_add_u32 v19, s10, v19
    s_lshl_b32 s10, s2, 4
    v_writelane_b32 v19, s10, 4
    s_mov_b32 s11, 0x00140000
    s_mov_b64 s[28:29], 31
Lm_c3:
    s_mov_b64 exec, s[28:29]
    buffer_store_dwordx4 v[184:187], v19, s[60:63], s11 offen sc1
    s_mov_b64 exec, -1
    v_and_b32 v18, 3, v1
    v_lshlrev_b32 v3, 12, v17
    v_lshrrev_b32 v24, 1, v16
    v_lshl_add_u32 v3, v24, 8, v3
    v_and_b32 v24, 1, v16
    v_lshl_add_u32 v3, v24, 3, v3
    v_lshlrev_b32 v14, 4, v24
    s_mul_i32 s10, s3, 1056
    s_add_u32 s10, s10, 94208
    v_add_u32 v8, s10, v2
    s_lshl_b32 s10, s5, 8
    s_add_u32 s10, s10, 94208
    v_mul_u32_u24 v25, 1056, v18
    v_lshl_add_u32 v25, v16, 4, v25
    v_add_u32 v9, s10, v25
    v_mov_b32 v15, 0x3b000000
    v_mov_b32 v180, 0x3f803f80
    v_mov_b32 v181, 0x3f803f80
    v_mov_b32 v182, 0x3f803f80
    v_mov_b32 v183, 0x3f803f80
    s_and_b32 s11, s6, 1
    s_lshr_b32 s12, s6, 1
    s_lshl_b32 s18, s11, 11
    s_lshl_b32 s10, s3, 9
    s_add_u32 s18, s18, s10
    s_lshl_b32 s10, s5, 6
    s_add_u32 s18, s18, s10
    s_lshl_b32 s10, s12, 4
    s_add_u32 s18, s18, s10
    v_bfe_u32 v24, v1, 2, 2
    v_lshl_add_u32 v24, v16, 3, v24
    v_lshlrev_b32 v24, 7, v24
    v_bfe_u32 v25, v1, 3, 2
    v_lshlrev_b32 v25, 1, v25
    v_bfe_u32 v26, v1, 1, 1
    v_xor_b32 v25, v25, v26
    v_lshl_add_u32 v24, v25, 4, v24
    v_and_b32 v26, 1, v1
    v_lshl_add_u32 v28, v26, 3, v24
    s_mov_b32 s34, 0x000f000f
    s_mov_b32 s35, 0x000f000f
    s_mov_b32 s8, 0
    s_add_u32 s18, s18, s7
    s_add_u32 s18, s18, 33792
    v_lshrrev_b32 v24, 3, v1
    v_and_b32 v25, 7, v1
    v_and_b32 v26, 1, v16
    v_lshlrev_b32 v26, 1, v26
    v_xor_b32 v25, v25, v26
    v_lshlrev_b32 v25, 4, v25
    v_lshl_add_u32 v22, v24, 10, v25
    v_xor_b32 v23, 64, v22
    v_and_b32 v19, 7, v1
    v_lshrrev_b32 v25, 2, v1
    v_lshlrev_b32 v25, 7, v25
    v_lshl_add_u32 v4, v18, 2, v25
    v_lshlrev_b32 v25, 7, v16
    v_lshl_add_u32 v5, v19, 4, v25
    s_mul_i32 s10, s5, -8064
    s_mul_i32 s11, s3, -2016
    s_add_u32 s10, s10, s11
    s_add_u32 s10, s10, 32768
    v_add_u32 v25, s10, v14
    v_xor_b32 v26, 16, v25
    v_add_u32 v26, -512, v26
    v_cmp_gt_u32 vcc, 8, v17
    s_nop 1
    v_cndmask_b32 v14, v25, v5, vcc
    v_cndmask_b32 v27, v26, v5, vcc
    v_lshlrev_b32 v6, 1, v1
    v_lshlrev_b32 v25, 3, v16
    v_lshl_add_u32 v7, v19, 4, v25
    s_mul_i32 s10, s3, 2112
    s_add_u32 s10, s10, 28672
    v_mul_u32_u24 v25, 528, v18
    v_lshl_add_u32 v25, v16, 4, v25
    v_lshrrev_b32 v26, 2, v17
    v_lshl_add_u32 v25, v26, 7, v25
    v_add_u32 v10, s10, v25
    s_mul_i32 s10, s3, 528
    s_add_u32 s10, s10, 28672
    v_lshlrev_b32 v25, 3, v1
    v_add_u32 v11, s10, v25
    s_lshl_b32 s10, s3, 3
    s_add_u32 s10, s10, 37120
    v_lshlrev_b32 v25, 5, v18
    v_add_u32 v12, s10, v25
    s_lshl_b32 s10, s3, 5
    s_add_u32 s10, s10, 37120
    v_mov_b32 v13, s10
    v_mov_b32 v25, 0x3f80
    v_mov_b32 v26, 0x3f800000
    v_cmp_eq_u32 vcc, 0, v17
    v_cmp_eq_u32 s[28:29], 1, v17
    s_nop 0
    v_cndmask_b32 v176, 0, v25, vcc
    v_cndmask_b32 v176, v176, v26, s[28:29]
    v_cmp_eq_u32 vcc, 2, v17
    v_cmp_eq_u32 s[28:29], 3, v17
    s_nop 0
    v_cndmask_b32 v177, 0, v25, vcc
    v_cndmask_b32 v177, v177, v26, s[28:29]
    v_cmp_eq_u32 vcc, 4, v17
    v_cmp_eq_u32 s[28:29], 5, v17
    s_nop 0
    v_cndmask_b32 v178, 0, v25, vcc
    v_cndmask_b32 v178, v178, v26, s[28:29]
    v_cmp_eq_u32 vcc, 6, v17
    v_cmp_eq_u32 s[28:29], 7, v17
    s_nop 0
    v_cndmask_b32 v179, 0, v25, vcc
    v_cndmask_b32 v179, v179, v26, s[28:29]
    v_mov_b32 v232, 0
    v_mov_b32 v233, 0
    v_mov_b32 v234, 0
    v_mov_b32 v235, 0
    v_mov_b32 v236, 0
    v_mov_b32 v237, 0
    v_mov_b32 v238, 0
    v_mov_b32 v239, 0
    v_mov_b32 v240, 0
    v_mov_b32 v241, 0
    v_mov_b32 v242, 0
    v_mov_b32 v243, 0
    v_mov_b32 v244, 0
    v_mov_b32 v245, 0
    v_mov_b32 v246, 0
    v_mov_b32 v247, 0
    s_mov_b32 s88, 0x000f000f
    s_mov_b32 s89, 0x000f000f
    s_mov_b32 s90, 0x00f000f0
    s_mov_b32 s91, 0x00f000f0
    s_mov_b32 s92, 0x0f000f00
    s_mov_b32 s93, 0x0f000f00
    s_mov_b32 s94, 0xf000f000
    s_mov_b32 s95, 0xf000f000
    s_lshl_b32 s20, s3, 13
    s_lshl_b32 s10, s5, 11
    s_add_u32 s20, s20, s10
    s_lshl_b32 s10, s6, 4
    s_add_u32 s20, s20, s10
    s_lshl_b32 s10, s4, 17
    s_add_u32 s20, s20, s10
    s_lshl_b32 s19, s5, 13
    s_lshl_b32 s10, s3, 11
    s_add_u32 s19, s19, s10
    s_lshl_b32 s10, s4, 17
    s_add_u32 s19, s19, s10
    s_add_u32 s17, s19, 0x00018000
    s_lshl_b32 s22, s3, 7
    s_lshl_b32 s10, s5, 5
    s_add_u32 s22, s22, s10
    s_lshl_b32 s10, s6, 2
    s_add_u32 s22, s22, s10
    s_lshl_b32 s10, s4, 17
    s_add_u32 s22, s22, s10
    s_add_u32 s22, s22, 0x00008000
    s_lshl_b32 s23, s3, 15
    s_lshl_b32 s10, s6, 12
    s_add_u32 s23, s23, s10
    s_lshl_b32 s10, s4, 9
    s_add_u32 s23, s23, s10
    s_lshl_b32 s10, s5, 7
    s_add_u32 s23, s23, s10
    s_add_u32 s23, s23, 0x00100000
    s_mov_b32 s24, 0x3e0293ee
    s_getreg_b32 s38, hwreg(HW_REG_XCC_ID, 0, 3)
    s_sub_u32 s25, s18, s7
    s_lshl_b32 s25, s25, 1
    s_add_u32 s25, s25, s7
    s_add_u32 s25, s25, 0x00007800
    v_lshlrev_b32 v21, 1, v3
    s_waitcnt vmcnt(9)
    s_branch Llnq
Lq_first:
    s_waitcnt vmcnt(5) lgkmcnt(0)
    v_mov_b32 v20, 1
    s_mov_b64 exec, 1
    ds_add_u32 v29, v20 offset:0
    s_mov_b64 exec, -1
    s_add_u32 m0, s85, s86
    s_add_u32 s16, s84, s86
    buffer_load_dwordx4 v224, s[44:47], s16 offen nt lds
    s_addk_i32 s86, 1024
    s_and_b32 s86, s86, 0x1fff
    s_add_u32 m0, s85, s86
    s_add_u32 s16, s84, s86
    buffer_load_dwordx4 v225, s[44:47], s16 offen nt lds
    s_addk_i32 s86, 1024
    s_and_b32 s86, s86, 0x1fff
    s_add_u32 m0, s85, s86
    s_add_u32 s16, s84, s86
    buffer_load_dwordx4 v226, s[44:47], s16 offen nt lds
    s_addk_i32 s86, 1024
    s_and_b32 s86, s86, 0x1fff
    s_add_u32 m0, s85, s86
    s_add_u32 s16, s84, s86
    buffer_load_dwordx4 v227, s[44:47], s16 offen nt lds
    s_addk_i32 s86, 1024
    s_and_b32 s86, s86, 0x1fff
    s_add_u32 s0, s39, 1
    s_mul_i32 s1, s0, 0x9E3779B1
    s_and_b32 s1, s1, -8
    s_or_b32 s38, s38, s1
    s_mov_b32 s12, 0x00100000
Ls3:
    ds_read_b32 v20, v29 offset:0
    s_waitcnt lgkmcnt(0)
    v_readfirstlane_b32 s11, v20
    s_cmp_ge_u32 s11, 8
    s_cbranch_scc1 Lt3
    s_sub_u32 s12, s12, 1
    s_cbranch_scc0 Ls3
Lt3:
    s_lshl_b32 s11, s3, 5
    v_xor_b32 v26, s11, v28
    ds_read_b64_tr_b16 v[96:97], v26 offset:12288
    ds_read_b64_tr_b16 v[98:99], v26 offset:12800
    ds_read_b64_tr_b16 v[100:101], v26 offset:16384
    ds_read_b64_tr_b16 v[102:103], v26 offset:16896
    ds_read_b64_tr_b16 v[104:105], v26 offset:20480
    ds_read_b64_tr_b16 v[106:107], v26 offset:20992
    ds_read_b64_tr_b16 v[108:109], v26 offset:24576
    ds_read_b64_tr_b16 v[110:111], v26 offset:25088
    s_waitcnt lgkmcnt(0)
    s_branch Lq_go
Lh_qst:
    v_mov_b32 v190, s0
    v_mov_b32 v191, s38
    buffer_store_dwordx4 v[188:191], v21, s[60:63], s25 offen
    s_add_u32 s25, s25, 0x00200000
    buffer_store_dwordx4 v[188:191], v21, s[60:63], s25 offen sc1
    s_mov_b64 exec, -1
    v_lshrrev_b32 v16, 4, v1
    v_and_b32 v17, 15, v1
    v_xor_b32 v24, v16, v17
    v_lshlrev_b32 v24, 4, v24
    v_lshl_add_u32 v24, v17, 8, v24
    s_lshl_b32 s11, s3, 13
    s_add_u32 s12, s11, 28672
    v_xor_b32 v18, 0, v24
    v_xor_b32 v19, 64, v24
    v_xor_b32 v20, 128, v24
    v_xor_b32 v21, 192, v24
    v_add_u32 v18, s12, v18
    v_add_u32 v19, s12, v19
    v_add_u32 v20, s12, v20
    v_add_u32 v21, s12, v21
    v_lshrrev_b32 v24, 2, v1
    v_and_b32 v25, 7, v24
    v_lshlrev_b32 v25, 1, v25
    v_bfe_u32 v26, v1, 1, 1
    v_xor_b32 v25, v25, v26
    v_lshlrev_b32 v25, 4, v25
    v_lshl_add_u32 v25, v24, 8, v25
    v_and_b32 v26, 1, v1
    v_lshl_add_u32 v25, v26, 3, v25
    s_add_u32 s12, s11, 61440
    v_xor_b32 v216, 0, v25
    v_xor_b32 v217, 32, v25
    v_xor_b32 v218, 64, v25
    v_xor_b32 v219, 96, v25
    v_xor_b32 v220, 128, v25
    v_xor_b32 v221, 160, v25
    v_xor_b32 v222, 192, v25
    v_xor_b32 v223, 224, v25
    v_add_u32 v216, s12, v216
    v_add_u32 v217, s12, v217
    v_add_u32 v218, s12, v218
    v_add_u32 v219, s12, v219
    v_add_u32 v220, s12, v220
    v_add_u32 v221, s12, v221
    v_add_u32 v222, s12, v222
    v_add_u32 v223, s12, v223
    s_lshl_b32 s14, s4, 19
    s_lshl_b32 s10, s5, 17
    s_add_u32 s14, s14, s10
    s_lshl_b32 s10, s3, 15
    s_add_u32 s14, s14, s10
    s_lshl_b32 s10, s6, 7
    s_add_u32 s14, s14, s10
    s_lshl_b32 s15, s3, 12
    s_add_u32 s15, s15, 45056
    s_lshl_b32 s13, s5, 10
    s_lshl_b32 s10, s6, 7
    s_add_u32 s13, s13, s10
    v_lshlrev_b32 v24, 5, v1
    s_lshl_b32 s12, s3, 10
    s_add_u32 s12, s12, 98432
    v_add_u32 v25, s12, v2
    v_add_u32 v26, 98432, v2
    s_waitcnt vmcnt(7)
    s_add_u32 m0, s87, s86
    s_add_u32 s16, s84, s86
    buffer_load_dwordx4 v228, s[48:51], s16 offen nt lds
    s_addk_i32 s86, 1024
    s_and_b32 s86, s86, 0x1fff
    s_waitcnt vmcnt(7)
    v_mov_b32 v16, 1
    s_mov_b64 exec, 1
    ds_add_u32 v29, v16 offset:8
    s_mov_b64 exec, -1
    s_add_u32 m0, s87, s86
    s_add_u32 s16, s84, s86
    buffer_load_dwordx4 v229, s[48:51], s16 offen nt lds
    s_addk_i32 s86, 1024
    s_and_b32 s86, s86, 0x1fff
    s_waitcnt vmcnt(7)
    s_cmp_lg_u32 s3, 0
    s_cbranch_scc1 Lnoflag
    s_mov_b32 s12, 0x00100000
Ls4:
    ds_read_b32 v16, v29 offset:8
    s_waitcnt lgkmcnt(0)
    v_readfirstlane_b32 s11, v16
    s_cmp_ge_u32 s11, 4
    s_cbranch_scc1 Lt4
    s_sub_u32 s12, s12, 1
    s_cbranch_scc0 Ls4
Lt4:
    v_mov_b32 v16, s0
    v_mov_b32 v17, s38
    s_lshl_b32 s11, s2, 4
    s_add_u32 s11, s11, 0x00148000
    s_mov_b64 exec, 1
    buffer_store_dwordx2 v[16:17], v232, s[60:63], s11 offen sc1
    s_mov_b64 exec, -1
Lnoflag:
    s_add_u32 m0, s87, s86
    s_add_u32 s16, s84, s86
    buffer_load_dwordx4 v228, s[48:51], s16 offen nt lds
    s_addk_i32 s86, 1024
    s_and_b32 s86, s86, 0x1fff
    s_waitcnt vmcnt(7)
    s_add_u32 m0, s87, s86
    s_add_u32 s16, s84, s86
    buffer_load_dwordx4 v229, s[48:51], s16 offen nt lds
    s_addk_i32 s86, 1024
    s_and_b32 s86, s86, 0x1fff
    s_waitcnt vmcnt(7)
    s_add_u32 m0, s87, s86
    s_add_u32 s16, s84, s86
    buffer_load_dwordx4 v228, s[48:51], s16 offen nt lds
    s_addk_i32 s86, 1024
    s_and_b32 s86, s86, 0x1fff
    s_waitcnt vmcnt(6)
    buffer_load_dwordx4 v[184:187], v24, s[60:63], s17 offen sc1
    buffer_load_dwordx4 v[188:191], v24, s[60:63], s17 offen offset:16 sc1
    s_waitcnt vmcnt(7)
    s_add_u32 m0, s87, s86
    s_add_u32 s16, s84, s86
    buffer_load_dwordx4 v229, s[48:51], s16 offen nt lds
    s_addk_i32 s86, 1024
    s_and_b32 s86, s86, 0x1fff
    s_waitcnt vmcnt(7)
    s_add_u32 m0, s87, s86
    s_add_u32 s16, s84, s86
    buffer_load_dwordx4 v228, s[48:51], s16 offen nt lds
    s_addk_i32 s86, 1024
    s_and_b32 s86, s86, 0x1fff
    s_waitcnt vmcnt(7)
    s_add_u32 m0, s87, s86
    s_add_u32 s16, s84, s86
    buffer_load_dwordx4 v229, s[48:51], s16 offen nt lds
    s_addk_i32 s86, 1024
    s_and_b32 s86, s86, 0x1fff
    buffer_load_dwordx4 v[192:195], v24, s[60:63], s17 offen sc1
    buffer_load_dwordx4 v[196:199], v24, s[60:63], s17 offen offset:16 sc1
    s_waitcnt vmcnt(14)
    ds_read_b128 v[32:35], v18 offset:0
    ds_read_b128 v[48:51], v18 offset:4096
    ds_read_b128 v[36:39], v19 offset:0
    ds_read_b128 v[52:55], v19 offset:4096
    ds_read_b128 v[40:43], v20 offset:0
    ds_read_b128 v[56:59], v20 offset:4096
    ds_read_b128 v[44:47], v21 offset:0
    ds_read_b128 v[60:63], v21 offset:4096
    s_waitcnt vmcnt(5)
    s_setprio 2
    s_mov_b32 s16, 0x00040000
    s_mov_b32 s37, 0
    s_mov_b32 s25, 0
Lmq:
    v_and_b32 v16, -8, v187
    v_and_b32 v17, -8, v191
    v_cmp_ne_u32 vcc, s0, v186
    v_cmp_ne_u32 s[32:33], s0, v190
    s_or_b64 vcc, vcc, s[32:33]
    v_cmp_ne_u32 s[32:33], s1, v16
    s_or_b64 vcc, vcc, s[32:33]
    v_cmp_ne_u32 s[32:33], s1, v17
    s_or_b64 vcc, vcc, s[32:33]
    s_cbranch_vccnz Lmqr
Lmqd:
    v_cmp_ne_u32 vcc, s38, v187
    v_mov_b32 v186, v188
    v_mov_b32 v187, v189
    ds_write_b128 v25, v[184:187]
    s_cmp_eq_u64 vcc, 0
    s_cselect_b32 s10, 1, 0x101
    v_mov_b32 v16, s10
    s_waitcnt lgkmcnt(0)
    s_mov_b64 exec, 1
    ds_add_u32 v29, v16 offset:4
    s_mov_b64 exec, -1
    s_cmp_eq_u32 s37, 0
    s_cbranch_scc1 Lnvf
    ds_read_b64_tr_b16 v[64:65], v216 offset:0
    ds_read_b64_tr_b16 v[66:67], v216 offset:4096
    ds_read_b64_tr_b16 v[68:69], v217 offset:0
    ds_read_b64_tr_b16 v[70:71], v217 offset:4096
    ds_read_b64_tr_b16 v[72:73], v218 offset:0
    ds_read_b64_tr_b16 v[74:75], v218 offset:4096
    ds_read_b64_tr_b16 v[76:77], v219 offset:0
    ds_read_b64_tr_b16 v[78:79], v219 offset:4096
    ds_read_b64_tr_b16 v[80:81], v220 offset:0
    ds_read_b64_tr_b16 v[82:83], v220 offset:4096
    ds_read_b64_tr_b16 v[84:85], v221 offset:0
    ds_read_b64_tr_b16 v[86:87], v221 offset:4096
    ds_read_b64_tr_b16 v[88:89], v222 offset:0
    ds_read_b64_tr_b16 v[90:91], v222 offset:4096
    ds_read_b64_tr_b16 v[92:93], v223 offset:0
    ds_read_b64_tr_b16 v[94:95], v223 offset:4096
Lnvf:
    buffer_load_dwordx2 v[254:255], v7, s[64:67], s13 offen
    s_lshl_b32 s25, s3, 10
    s_add_u32 s25, s25, 0x00148000
    s_lshl_b32 s17, s5, 12
    s_lshl_b32 s10, s4, 17
    s_add_u32 s17, s17, s10
    s_add_u32 s17, s17, 0x00008400
    s_add_u32 s10, s6, 0
    s_and_b32 s10, s10, 3
    s_lshl_b32 s84, s10, 10
    s_add_u32 s10, s6, 1
    s_and_b32 s10, s10, 3
    s_lshl_b32 s85, s10, 10
    s_add_u32 s10, s6, 2
    s_and_b32 s10, s10, 3
    s_lshl_b32 s86, s10, 10
    s_add_u32 s10, s6, 3
    s_and_b32 s10, s10, 3
    s_lshl_b32 s87, s10, 10
    s_and_b32 s10, s6, 1
    s_lshl_b32 s10, s10, 6
    v_xor_b32 v22, s10, v22
    v_xor_b32 v23, s10, v23
    s_lshl_b32 s13, s96, 2
    s_add_u32 s13, s13, s3
    s_lshl_b32 s13, s13, 8
    v_lshlrev_b32 v21, 7, v1
    v_add_u32 v21, s13, v21
    s_lshl_b32 s10, s3, 7
    s_add_u32 s10, s10, 32768
    v_writelane_b32 v21, s10, 2
    s_mov_b32 s12, 0x00100000
Ls5:
    ds_read_b32 v16, v29 offset:4
    s_waitcnt lgkmcnt(0)
    v_readfirstlane_b32 s11, v16
    s_and_b32 s10, s11, 255
    s_cmp_ge_u32 s10, 4
    s_cbranch_scc1 Lt5
    s_sub_u32 s12, s12, 1
    s_cbranch_scc0 Ls5
Lt5:
    s_cmp_lt_u32 s11, 256
    s_cselect_b32 s9, 1, 0
    ds_read_b128 v[200:203], v26 offset:0
    ds_read_b128 v[204:207], v26 offset:1024
    ds_read_b128 v[208:211], v26 offset:2048
    ds_read_b128 v[212:215], v26 offset:3072
    s_waitcnt lgkmcnt(3)
    v_mfma_f32_16x16x32_bf16 v[184:187], v[32:35], v[200:203], 0
    v_mfma_f32_16x16x32_bf16 v[188:191], v[48:51], v[200:203], 0
    s_waitcnt lgkmcnt(2)
    v_mfma_f32_16x16x32_bf16 v[184:187], v[36:39], v[204:207], v[184:187]
    v_mfma_f32_16x16x32_bf16 v[188:191], v[52:55], v[204:207], v[188:191]
    s_waitcnt lgkmcnt(1)
    v_mfma_f32_16x16x32_bf16 v[184:187], v[40:43], v[208:211], v[184:187]
    v_mfma_f32_16x16x32_bf16 v[188:191], v[56:59], v[208:211], v[188:191]
    s_waitcnt lgkmcnt(0)
    v_mfma_f32_16x16x32_bf16 v[184:187], v[44:47], v[212:215], v[184:187]
    v_mfma_f32_16x16x32_bf16 v[188:191], v[60:63], v[212:215], v[188:191]
    s_add_u32 m0, s15, s84
    s_lshl3_add_u32 s10, s84, s14
    buffer_load_dwordx4 v22, s[56:59], s10 offen nt lds
    s_add_u32 m0, s15, s85
    s_lshl3_add_u32 s10, s85, s14
    buffer_load_dwordx4 v23, s[56:59], s10 offen nt lds
    s_add_u32 m0, s15, s86
    s_lshl3_add_u32 s10, s86, s14
    buffer_load_dwordx4 v22, s[56:59], s10 offen nt lds
    s_add_u32 m0, s15, s87
    s_lshl3_add_u32 s10, s87, s14
    buffer_load_dwordx4 v23, s[56:59], s10 offen nt lds
    s_mov_b64 exec, 7
    buffer_load_dword v224, v21, s[60:63], s7 offen sc1
    s_mov_b64 exec, -1
    s_branch Lk_go
Llnq:
    v_dot2_f32_bf16 v16, v248, v180, 0
    v_dot2_f32_bf16 v17, v248, v248, 0
    v_dot2_f32_bf16 v16, v249, v180, v16
    v_dot2_f32_bf16 v17, v249, v249, v17
    v_dot2_f32_bf16 v16, v250, v180, v16
    v_dot2_f32_bf16 v17, v250, v250, v17
    v_dot2_f32_bf16 v16, v251, v180, v16
    v_dot2_f32_bf16 v17, v251, v251, v17
    v_lshlrev_b32 v184, 16, v248
    v_and_b32 v185, 0xffff0000, v248
    v_lshlrev_b32 v186, 16, v249
    v_add_f32_dpp v16, v16, v16 row_ror:8 row_mask:0xf bank_mask:0xf
    v_add_f32_dpp v17, v17, v17 row_ror:8 row_mask:0xf bank_mask:0xf
    v_and_b32 v187, 0xffff0000, v249
    v_add_f32_dpp v16, v16, v16 row_ror:4 row_mask:0xf bank_mask:0xf
    v_add_f32_dpp v17, v17, v17 row_ror:4 row_mask:0xf bank_mask:0xf
    v_lshlrev_b32 v188, 16, v250
    v_add_f32_dpp v16, v16, v16 row_ror:2 row_mask:0xf bank_mask:0xf
    v_add_f32_dpp v17, v17, v17 row_ror:2 row_mask:0xf bank_mask:0xf
    v_and_b32 v189, 0xffff0000, v250
    v_add_f32_dpp v16, v16, v16 row_ror:1 row_mask:0xf bank_mask:0xf
    v_add_f32_dpp v17, v17, v17 row_ror:1 row_mask:0xf bank_mask:0xf
    v_lshlrev_b32 v190, 16, v251
    v_add_f32_dpp v16, v16, v16 row_bcast:15 row_mask:0xa bank_mask:0xf
    v_add_f32_dpp v17, v17, v17 row_bcast:15 row_mask:0xa bank_mask:0xf
    v_and_b32 v191, 0xffff0000, v251
    v_add_f32_dpp v16, v16, v16 row_bcast:31 row_mask:0xc bank_mask:0xf
    v_add_f32_dpp v17, v17, v17 row_bcast:31 row_mask:0xc bank_mask:0xf
    s_nop 0
    v_readlane_b32 s26, v16, 63
    v_readlane_b32 s27, v17, 63
    s_nop 0
    v_mul_f32 v16, s26, v15
    v_mul_f32 v17, s27, v15
    v_fma_f32 v17, -v16, v16, v17
    v_max_f32 v17, 0, v17
    v_add_f32 v17, 0x3727c5ac, v17
    v_rsq_f32 v18, v17
    s_cmp_eq_u32 s8, 0
    v_mul_f32 v19, v16, v18
    v_pk_fma_f32 v[184:185], v[184:185], v[18:19], v[18:19] op_sel:[0,0,1] op_sel_hi:[1,0,1] neg_lo:[0,0,1] neg_hi:[0,0,1]
    v_pk_fma_f32 v[186:187], v[186:187], v[18:19], v[18:19] op_sel:[0,0,1] op_sel_hi:[1,0,1] neg_lo:[0,0,1] neg_hi:[0,0,1]
    v_pk_fma_f32 v[188:189], v[188:189], v[18:19], v[18:19] op_sel:[0,0,1] op_sel_hi:[1,0,1] neg_lo:[0,0,1] neg_hi:[0,0,1]
    v_pk_fma_f32 v[190:191], v[190:191], v[18:19], v[18:19] op_sel:[0,0,1] op_sel_hi:[1,0,1] neg_lo:[0,0,1] neg_hi:[0,0,1]
    v_cvt_pk_bf16_f32 v192, v184, v185
    v_cvt_pk_bf16_f32 v193, v186, v187
    v_cvt_pk_bf16_f32 v194, v188, v189
    v_cvt_pk_bf16_f32 v195, v190, v191
    ds_write_b128 v8, v[192:195]
    s_cbranch_scc1 Lq_first
    s_waitcnt lgkmcnt(0)
    s_barrier
Lq_go:
    ds_read_b128 v[200:203], v9 offset:0
    ds_read_b128 v[204:207], v9 offset:64
    ds_read_b128 v[208:211], v9 offset:128
    ds_read_b128 v[212:215], v9 offset:192
    s_waitcnt lgkmcnt(3)
    v_mfma_f32_16x16x32_bf16 v[184:187], v[96:99], v[200:203], 0
    s_waitcnt lgkmcnt(2)
    v_mfma_f32_16x16x32_bf16 v[184:187], v[100:103], v[204:207], v[184:187]
    s_waitcnt lgkmcnt(1)
    v_mfma_f32_16x16x32_bf16 v[184:187], v[104:107], v[208:211], v[184:187]
    s_waitcnt lgkmcnt(0)
    v_mfma_f32_16x16x32_bf16 v[184:187], v[108:111], v[212:215], v[184:187]
    s_cmp_eq_u32 s8, 0
    s_mov_b64 exec, s[34:35]
    s_nop 5
    v_cvt_pk_bf16_f32 v188, v184, v185
    v_cvt_pk_bf16_f32 v189, v186, v187
    s_cbranch_scc1 Lh_qst
    s_cmp_eq_u32 s9, 0
    s_cbranch_scc1 Lw6
    buffer_store_dwordx2 v[188:189], v3, s[60:63], s18 offen
Lx6:
    s_mov_b64 exec, -1
    ds_write_b128 v8, v[248:251] offset:4224
    s_mov_b32 s37, 0
    s_add_u32 s19, s19, 50176
    s_add_u32 s20, s20, 50176
    s_add_u32 s22, s22, 50176
    s_add_u32 s23, s23, 131072
    s_mov_b32 s16, 0x00040000
    s_waitcnt vmcnt(0)
Lp7:
    buffer_load_dwordx4 v[200:203], v2, s[60:63], s17 offen offset:0 sc1
    buffer_load_dwordx4 v[204:207], v2, s[60:63], s17 offen offset:1024 sc1
    buffer_load_dwordx4 v[208:211], v2, s[60:63], s17 offen offset:2048 sc1
    buffer_load_dwordx4 v[212:215], v2, s[60:63], s17 offen offset:3072 sc1
    s_waitcnt vmcnt(3)
    v_mfma_f32_16x16x32_bf16 v[184:187], v[32:35], v[200:203], 0
    v_max3_u32 v17, v200, v201, v202
    v_mfma_f32_16x16x32_bf16 v[188:191], v[48:51], v[200:203], 0
    v_max_u32 v16, v17, v203
    s_waitcnt vmcnt(2)
    v_mfma_f32_16x16x32_bf16 v[184:187], v[36:39], v[204:207], v[184:187]
    v_max3_u32 v17, v204, v205, v206
    v_mfma_f32_16x16x32_bf16 v[188:191], v[52:55], v[204:207], v[188:191]
    v_max3_u32 v16, v16, v17, v207
    s_waitcnt vmcnt(1)
    v_mfma_f32_16x16x32_bf16 v[184:187], v[40:43], v[208:211], v[184:187]
    v_max3_u32 v17, v208, v209, v210
    v_mfma_f32_16x16x32_bf16 v[188:191], v[56:59], v[208:211], v[188:191]
    v_max3_u32 v16, v16, v17, v211
    s_waitcnt vmcnt(0)
    v_mfma_f32_16x16x32_bf16 v[184:187], v[44:47], v[212:215], v[184:187]
    v_max3_u32 v17, v212, v213, v214
    v_mfma_f32_16x16x32_bf16 v[188:191], v[60:63], v[212:215], v[188:191]
    v_max3_u32 v16, v16, v17, v215
    v_cmp_eq_u32 vcc, -1, v16
    s_cbranch_vccz Ld7
    buffer_load_dwordx4 v[216:219], v2, s[60:63], s17 offen offset:0 sc1
    buffer_load_dwordx4 v[220:223], v2, s[60:63], s17 offen offset:1024 sc1
    buffer_load_dwordx4 v[224:227], v2, s[60:63], s17 offen offset:2048 sc1
    buffer_load_dwordx4 v[228:231], v2, s[60:63], s17 offen offset:3072 sc1
    s_sub_u32 s16, s16, 1
    s_waitcnt vmcnt(3)
    v_mfma_f32_16x16x32_bf16 v[184:187], v[32:35], v[216:219], 0
    v_max3_u32 v17, v216, v217, v218
    v_mfma_f32_16x16x32_bf16 v[188:191], v[48:51], v[216:219], 0
    v_max_u32 v16, v17, v219
    s_waitcnt vmcnt(2)
    v_mfma_f32_16x16x32_bf16 v[184:187], v[36:39], v[220:223], v[184:187]
    v_max3_u32 v17, v220, v221, v222
    v_mfma_f32_16x16x32_bf16 v[188:191], v[52:55], v[220:223], v[188:191]
    v_max3_u32 v16, v16, v17, v223
    s_waitcnt vmcnt(1)
    v_mfma_f32_16x16x32_bf16 v[184:187], v[40:43], v[224:227], v[184:187]
    v_max3_u32 v17, v224, v225, v226
    v_mfma_f32_16x16x32_bf16 v[188:191], v[56:59], v[224:227], v[188:191]
    v_max3_u32 v16, v16, v17, v227
    s_waitcnt vmcnt(0)
    v_mfma_f32_16x16x32_bf16 v[184:187], v[44:47], v[228:231], v[184:187]
    v_max3_u32 v17, v228, v229, v230
    v_mfma_f32_16x16x32_bf16 v[188:191], v[60:63], v[228:231], v[188:191]
    v_max3_u32 v16, v16, v17, v231
    v_cmp_eq_u32 vcc, -1, v16
    s_cbranch_vccz Ld7
    s_sub_u32 s16, s16, 1
    s_cmp_gt_i32 s16, 0
    s_cbranch_scc1 Lp7
    s_branch Lsk_k
.p2align 6
Lst_k:
    s_setpc_b64 s[32:33]
Lsk_k:
Ld7:
Lk_go:
    s_nop 4
    v_add_f32_dpp v184, v184, v184 row_ror:4 row_mask:0xf bank_mask:0xf
    v_add_f32_dpp v185, v185, v185 row_ror:4 row_mask:0xf bank_mask:0xf
    v_add_f32_dpp v186, v186, v186 row_ror:4 row_mask:0xf bank_mask:0xf
    v_add_f32_dpp v187, v187, v187 row_ror:4 row_mask:0xf bank_mask:0xf
    v_add_f32_dpp v188, v188, v188 row_ror:4 row_mask:0xf bank_mask:0xf
    v_add_f32_dpp v189, v189, v189 row_ror:4 row_mask:0xf bank_mask:0xf
    v_add_f32_dpp v190, v190, v190 row_ror:4 row_mask:0xf bank_mask:0xf
    v_add_f32_dpp v191, v191, v191 row_ror:4 row_mask:0xf bank_mask:0xf
    v_add_f32_dpp v184, v184, v184 row_ror:8 row_mask:0xf bank_mask:0xf
    v_add_f32_dpp v185, v185, v185 row_ror:8 row_mask:0xf bank_mask:0xf
    v_add_f32_dpp v186, v186, v186 row_ror:8 row_mask:0xf bank_mask:0xf
    v_add_f32_dpp v187, v187, v187 row_ror:8 row_mask:0xf bank_mask:0xf
    v_add_f32_dpp v188, v188, v188 row_ror:8 row_mask:0xf bank_mask:0xf
    v_add_f32_dpp v189, v189, v189 row_ror:8 row_mask:0xf bank_mask:0xf
    v_add_f32_dpp v190, v190, v190 row_ror:8 row_mask:0xf bank_mask:0xf
    v_add_f32_dpp v191, v191, v191 row_ror:8 row_mask:0xf bank_mask:0xf
    v_max3_f32 v16, v184, v185, v186
    v_max3_f32 v17, v187, v188, v189
    v_max3_f32 v16, v16, v190, v191
    v_max_f32 v16, v16, v17
    v_mov_b32 v17, v16
    s_nop 1
    v_permlane16_swap_b32 v16, v17
    v_max_f32 v16, v16, v17
    v_mov_b32 v17, v16
    s_nop 1
    v_permlane32_swap_b32 v16, v17
    v_max_f32 v16, v16, v17
    v_mul_f32 v18, s24, v16
    v_fma_f32 v184, v184, s24, -v18
    v_fma_f32 v185, v185, s24, -v18
    v_fma_f32 v186, v186, s24, -v18
    v_fma_f32 v187, v187, s24, -v18
    v_fma_f32 v188, v188, s24, -v18
    v_fma_f32 v189, v189, s24, -v18
    v_fma_f32 v190, v190, s24, -v18
    v_fma_f32 v191, v191, s24, -v18
    v_exp_f32 v184, v184
    v_exp_f32 v185, v185
    v_exp_f32 v186, v186
    v_exp_f32 v187, v187
    v_exp_f32 v188, v188
    v_exp_f32 v189, v189
    v_exp_f32 v190, v190
    v_exp_f32 v191, v191
    s_mov_b64 exec, s[88:89]
    v_cvt_pk_bf16_f32 v232, v184, v185
    v_cvt_pk_bf16_f32 v233, v186, v187
    v_cvt_pk_bf16_f32 v234, v188, v189
    v_cvt_pk_bf16_f32 v235, v190, v191
    s_mov_b64 exec, s[90:91]
    v_cvt_pk_bf16_f32 v236, v184, v185
    v_cvt_pk_bf16_f32 v237, v186, v187
    v_cvt_pk_bf16_f32 v238, v188, v189
    v_cvt_pk_bf16_f32 v239, v190, v191
    s_mov_b64 exec, s[92:93]
    v_cvt_pk_bf16_f32 v240, v184, v185
    v_cvt_pk_bf16_f32 v241, v186, v187
    v_cvt_pk_bf16_f32 v242, v188, v189
    v_cvt_pk_bf16_f32 v243, v190, v191
    s_mov_b64 exec, s[94:95]
    v_cvt_pk_bf16_f32 v244, v184, v185
    v_cvt_pk_bf16_f32 v245, v186, v187
    v_cvt_pk_bf16_f32 v246, v188, v189
    v_cvt_pk_bf16_f32 v247, v190, v191
    s_mov_b64 exec, -1
    s_cmp_lg_u32 s8, 0
    s_cbranch_scc1 Lv_go
    s_waitcnt vmcnt(6)
    buffer_load_dwordx4 v[228:231], v2, s[60:63], s25 offen sc1
    s_cmp_lg_u32 s37, 0
    s_cbranch_scc1 Lv_have
    ds_read_b64_tr_b16 v[64:65], v216 offset:0
    ds_read_b64_tr_b16 v[66:67], v216 offset:4096
    ds_read_b64_tr_b16 v[68:69], v217 offset:0
    ds_read_b64_tr_b16 v[70:71], v217 offset:4096
    ds_read_b64_tr_b16 v[72:73], v218 offset:0
    ds_read_b64_tr_b16 v[74:75], v218 offset:4096
    ds_read_b64_tr_b16 v[76:77], v219 offset:0
    ds_read_b64_tr_b16 v[78:79], v219 offset:4096
    ds_read_b64_tr_b16 v[80:81], v220 offset:0
    ds_read_b64_tr_b16 v[82:83], v220 offset:4096
    ds_read_b64_tr_b16 v[84:85], v221 offset:0
    ds_read_b64_tr_b16 v[86:87], v221 offset:4096
    ds_read_b64_tr_b16 v[88:89], v222 offset:0
    ds_read_b64_tr_b16 v[90:91], v222 offset:4096
    ds_read_b64_tr_b16 v[92:93], v223 offset:0
    ds_read_b64_tr_b16 v[94:95], v223 offset:4096
    s_waitcnt lgkmcnt(0)
Lv_have:
    s_cmp_lg_u32 s8, 0
Lv_go:
    v_mfma_f32_16x16x32_bf16 v[200:203], v[180:183], v[232:235], 0
    v_mfma_f32_16x16x32_bf16 v[192:195], v[64:67], v[232:235], 0
    v_mfma_f32_16x16x32_bf16 v[196:199], v[68:71], v[232:235], 0
    v_mfma_f32_16x16x32_bf16 v[192:195], v[72:75], v[236:239], v[192:195]
    v_mfma_f32_16x16x32_bf16 v[196:199], v[76:79], v[236:239], v[196:199]
    v_mfma_f32_16x16x32_bf16 v[192:195], v[80:83], v[240:243], v[192:195]
    v_mfma_f32_16x16x32_bf16 v[196:199], v[84:87], v[240:243], v[196:199]
    v_mfma_f32_16x16x32_bf16 v[192:195], v[88:91], v[244:247], v[192:195]
    v_mfma_f32_16x16x32_bf16 v[196:199], v[92:95], v[244:247], v[196:199]
    s_mov_b64 exec, s[34:35]
    v_mov_b32 v19, v200
    ds_write_b64 v12, v[18:19]
    s_mov_b64 exec, -1
    s_nop 2
    ds_write_b128 v10, v[192:195]
    ds_write_b128 v10, v[196:199] offset:64
    s_waitcnt lgkmcnt(0)
    s_cbranch_scc1 Lrb_bar
    v_mov_b32 v20, 1
    s_mov_b64 exec, 1
    ds_add_u32 v29, v20 offset:12
    s_mov_b64 exec, -1
    s_mov_b32 s12, 0x00100000
Ls8:
    ds_read_b32 v20, v29 offset:12
    s_waitcnt lgkmcnt(0)
    v_readfirstlane_b32 s11, v20
    s_cmp_ge_u32 s11, 4
    s_cbranch_scc1 Lt8
    s_sub_u32 s12, s12, 1
    s_cbranch_scc0 Ls8
Lt8:
    s_branch Lrb_go
Lrb_bar:
    s_barrier
Lrb_go:
    ds_read_b128 v[184:187], v13
    ds_read_b128 v[188:191], v13 offset:16
    ds_read_b64 v[192:193], v11 offset:0
    ds_read_b64 v[194:195], v11 offset:2112
    ds_read_b64 v[196:197], v11 offset:4224
    ds_read_b64 v[198:199], v11 offset:6336
    v_mov_b32 v20, 0
    s_cmp_eq_u32 s9, 0
    s_waitcnt lgkmcnt(4)
    v_max3_f32 v16, v184, v186, v188
    v_max_f32 v16, v16, v190
    v_sub_f32 v184, v184, v16
    v_sub_f32 v186, v186, v16
    v_sub_f32 v188, v188, v16
    v_sub_f32 v190, v190, v16
    v_exp_f32 v184, v184
    v_exp_f32 v186, v186
    v_exp_f32 v188, v188
    v_exp_f32 v190, v190
    v_mul_f32 v17, v184, v185
    v_fmac_f32 v17, v186, v187
    v_fmac_f32 v17, v188, v189
    v_fmac_f32 v17, v190, v191
    s_waitcnt lgkmcnt(0)
    v_pk_mul_f32 v[192:193], v[192:193], v[184:185] op_sel_hi:[1,0]
    v_rcp_f32 v18, v17
    v_pk_fma_f32 v[192:193], v[194:195], v[186:187], v[192:193] op_sel_hi:[1,0,1]
    v_log_f32 v21, v17
    v_pk_fma_f32 v[192:193], v[196:197], v[188:189], v[192:193] op_sel_hi:[1,0,1]
    v_pk_fma_f32 v[192:193], v[198:199], v[190:191], v[192:193] op_sel_hi:[1,0,1]
    v_pk_mul_f32 v[192:193], v[192:193], v[18:19] op_sel_hi:[1,0]
    v_add_f32 v21, v21, v16
    v_cvt_pk_bf16_f32 v192, v192, v193
    s_cbranch_scc1 Lw9
    buffer_store_dword v192, v4, s[60:63], s20 offen
Lx9:
    s_mov_b64 exec, 1
    s_cbranch_scc1 Lw10
    buffer_store_dword v21, v20, s[60:63], s22 offen
Lx10:
    s_mov_b64 exec, -1
    s_cmp_lg_u32 s8, 0
    s_cbranch_scc1 Lo_go
    s_waitcnt vmcnt(2)
    s_mov_b32 s14, 0x00040000
Lap:
    v_and_b32 v24, -8, v229
    v_cmp_ne_u32 vcc, s0, v228
    v_cmp_ne_u32 s[28:29], s1, v24
    s_or_b64 vcc, vcc, s[28:29]
    s_cbranch_vccnz Lar
Lad:
    v_mov_b32 v24, 1
    s_mov_b64 exec, 1
    ds_add_u32 v29, v24 offset:16
    s_mov_b64 exec, -1
    v_lshlrev_b32 v224, 16, v254
    v_and_b32 v225, 0xffff0000, v254
    v_lshlrev_b32 v226, 16, v255
    v_and_b32 v227, 0xffff0000, v255
    v_mov_b32 v252, v224
    v_mov_b32 v253, v225
    v_mov_b32 v254, v226
    v_mov_b32 v255, v227
    v_xor_b32 v224, 0, v28
    v_xor_b32 v225, 32, v28
    v_xor_b32 v226, 64, v28
    v_xor_b32 v227, 96, v28
    v_add_u32 v224, 45056, v224
    v_add_u32 v225, 45056, v225
    v_add_u32 v226, 45056, v226
    v_add_u32 v227, 45056, v227
    s_mov_b32 s12, 0x00100000
Ls11:
    ds_read_b32 v24, v29 offset:16
    s_waitcnt lgkmcnt(0)
    v_readfirstlane_b32 s11, v24
    s_cmp_ge_u32 s11, 4
    s_cbranch_scc1 Lt11
    s_sub_u32 s12, s12, 1
    s_cbranch_scc0 Ls11
Lt11:
    s_mov_b32 s37, 1
Lo_go:
    s_mov_b32 s14, 0x55555555
    s_mov_b32 s15, 0x55555555
    s_mov_b32 s16, 0x00040000
    s_waitcnt vmcnt(0)
Lp12:
    buffer_load_dwordx4 v[184:187], v14, s[60:63], s19 offen offset:0 sc1
    buffer_load_dwordx4 v[188:191], v27, s[60:63], s19 offen offset:512 sc1
    buffer_load_dwordx4 v[192:195], v5, s[60:63], s19 offen offset:1024 sc1
    buffer_load_dwordx4 v[196:199], v5, s[60:63], s19 offen offset:1536 sc1
    s_cmp_eq_u32 s37, 0
    s_cbranch_scc1 Lo_nof
    s_mov_b32 s37, 0
    ds_read_b64_tr_b16 v[112:113], v224 offset:0
    ds_read_b64_tr_b16 v[114:115], v224 offset:512
    ds_read_b64_tr_b16 v[128:129], v225 offset:0
    ds_read_b64_tr_b16 v[130:131], v225 offset:512
    ds_read_b64_tr_b16 v[144:145], v226 offset:0
    ds_read_b64_tr_b16 v[146:147], v226 offset:512
    ds_read_b64_tr_b16 v[160:161], v227 offset:0
    ds_read_b64_tr_b16 v[162:163], v227 offset:512
    ds_read_b64_tr_b16 v[116:117], v224 offset:4096
    ds_read_b64_tr_b16 v[118:119], v224 offset:4608
    ds_read_b64_tr_b16 v[132:133], v225 offset:4096
    ds_read_b64_tr_b16 v[134:135], v225 offset:4608
    ds_read_b64_tr_b16 v[148:149], v226 offset:4096
    ds_read_b64_tr_b16 v[150:151], v226 offset:4608
    ds_read_b64_tr_b16 v[164:165], v227 offset:4096
    ds_read_b64_tr_b16 v[166:167], v227 offset:4608
    ds_read_b64_tr_b16 v[120:121], v224 offset:8192
    ds_read_b64_tr_b16 v[122:123], v224 offset:8704
    ds_read_b64_tr_b16 v[136:137], v225 offset:8192
    ds_read_b64_tr_b16 v[138:139], v225 offset:8704
    ds_read_b64_tr_b16 v[152:153], v226 offset:8192
    ds_read_b64_tr_b16 v[154:155], v226 offset:8704
    ds_read_b64_tr_b16 v[168:169], v227 offset:8192
    ds_read_b64_tr_b16 v[170:171], v227 offset:8704
    ds_read_b64_tr_b16 v[124:125], v224 offset:12288
    ds_read_b64_tr_b16 v[126:127], v224 offset:12800
    ds_read_b64_tr_b16 v[140:141], v225 offset:12288
    ds_read_b64_tr_b16 v[142:143], v225 offset:12800
    ds_read_b64_tr_b16 v[156:157], v226 offset:12288
    ds_read_b64_tr_b16 v[158:159], v226 offset:12800
    ds_read_b64_tr_b16 v[172:173], v227 offset:12288
    ds_read_b64_tr_b16 v[174:175], v227 offset:12800
Lo_nof:
    s_waitcnt vmcnt(3)
    s_waitcnt lgkmcnt(15)
    v_max3_u32 v17, v184, v185, v186
    v_mfma_f32_16x16x32_bf16 v[96:99], v[184:187], v[112:115], 0
    v_max_u32 v16, v17, v187
    v_mfma_f32_16x16x32_bf16 v[100:103], v[184:187], v[128:131], 0
    v_mfma_f32_16x16x32_bf16 v[104:107], v[184:187], v[144:147], 0
    v_mfma_f32_16x16x32_bf16 v[108:111], v[184:187], v[160:163], 0
    s_waitcnt vmcnt(2)
    v_mfma_f32_16x16x32_bf16 v[96:99], v[188:191], v[116:119], v[96:99]
    v_max3_u32 v17, v188, v189, v190
    v_max3_f32 v18, v184, v185, v186
    v_max3_u32 v16, v16, v17, v191
    v_max3_f32 v19, v187, v188, v189
    v_mfma_f32_16x16x32_bf16 v[100:103], v[188:191], v[132:135], v[100:103]
    v_max3_f32 v18, v18, v190, v191
    v_max_f32 v18, v18, v19
    v_mfma_f32_16x16x32_bf16 v[104:107], v[188:191], v[148:151], v[104:107]
    v_mfma_f32_16x16x32_bf16 v[108:111], v[188:191], v[164:167], v[108:111]
    s_waitcnt vmcnt(1)
    s_waitcnt lgkmcnt(8)
    v_max3_u32 v17, v192, v193, v194
    v_mfma_f32_16x16x32_bf16 v[96:99], v[192:195], v[120:123], v[96:99]
    v_max3_u32 v16, v16, v17, v195
    v_sub_f32 v216, v184, v18
    v_sub_f32 v217, v185, v18
    v_mfma_f32_16x16x32_bf16 v[100:103], v[192:195], v[136:139], v[100:103]
    v_sub_f32 v218, v186, v18
    v_sub_f32 v219, v187, v18
    v_mfma_f32_16x16x32_bf16 v[104:107], v[192:195], v[152:155], v[104:107]
    v_exp_f32 v216, v216
    v_exp_f32 v217, v217
    v_mfma_f32_16x16x32_bf16 v[108:111], v[192:195], v[168:171], v[108:111]
    v_exp_f32 v218, v218
    v_exp_f32 v219, v219
    s_waitcnt vmcnt(0)
    s_waitcnt lgkmcnt(0)
    v_max3_u32 v17, v196, v197, v198
    v_mfma_f32_16x16x32_bf16 v[96:99], v[196:199], v[124:127], v[96:99]
    v_max3_u32 v16, v16, v17, v199
    v_mov_b32_dpp v216, v216 row_ror:8 row_mask:0xf bank_mask:0x3
    v_mov_b32_dpp v217, v217 row_ror:8 row_mask:0xf bank_mask:0x3
    v_mfma_f32_16x16x32_bf16 v[100:103], v[196:199], v[140:143], v[100:103]
    v_mov_b32_dpp v218, v218 row_ror:8 row_mask:0xf bank_mask:0x3
    v_mov_b32_dpp v219, v219 row_ror:8 row_mask:0xf bank_mask:0x3
    v_mfma_f32_16x16x32_bf16 v[104:107], v[196:199], v[156:159], v[104:107]
    v_add_f32 v18, v216, v217
    v_add_f32 v19, v218, v219
    v_mfma_f32_16x16x32_bf16 v[108:111], v[196:199], v[172:175], v[108:111]
    v_add_f32 v18, v18, v19
    v_mov_b32 v19, v18
    v_cmp_eq_u32 vcc, -1, v16
    s_cbranch_vccz Ld12
    buffer_load_dwordx4 v[200:203], v14, s[60:63], s19 offen offset:0 sc1
    buffer_load_dwordx4 v[204:207], v27, s[60:63], s19 offen offset:512 sc1
    buffer_load_dwordx4 v[208:211], v5, s[60:63], s19 offen offset:1024 sc1
    buffer_load_dwordx4 v[212:215], v5, s[60:63], s19 offen offset:1536 sc1
    s_sub_u32 s16, s16, 1
    s_waitcnt vmcnt(3)
    s_waitcnt lgkmcnt(15)
    v_max3_u32 v17, v200, v201, v202
    v_mfma_f32_16x16x32_bf16 v[96:99], v[200:203], v[112:115], 0
    v_max_u32 v16, v17, v203
    v_mfma_f32_16x16x32_bf16 v[100:103], v[200:203], v[128:131], 0
    v_mfma_f32_16x16x32_bf16 v[104:107], v[200:203], v[144:147], 0
    v_mfma_f32_16x16x32_bf16 v[108:111], v[200:203], v[160:163], 0
    s_waitcnt vmcnt(2)
    v_mfma_f32_16x16x32_bf16 v[96:99], v[204:207], v[116:119], v[96:99]
    v_max3_u32 v17, v204, v205, v206
    v_max3_f32 v18, v200, v201, v202
    v_max3_u32 v16, v16, v17, v207
    v_max3_f32 v19, v203, v204, v205
    v_mfma_f32_16x16x32_bf16 v[100:103], v[204:207], v[132:135], v[100:103]
    v_max3_f32 v18, v18, v206, v207
    v_max_f32 v18, v18, v19
    v_mfma_f32_16x16x32_bf16 v[104:107], v[204:207], v[148:151], v[104:107]
    v_mfma_f32_16x16x32_bf16 v[108:111], v[204:207], v[164:167], v[108:111]
    s_waitcnt vmcnt(1)
    s_waitcnt lgkmcnt(8)
    v_max3_u32 v17, v208, v209, v210
    v_mfma_f32_16x16x32_bf16 v[96:99], v[208:211], v[120:123], v[96:99]
    v_max3_u32 v16, v16, v17, v211
    v_sub_f32 v216, v200, v18
    v_sub_f32 v217, v201, v18
    v_mfma_f32_16x16x32_bf16 v[100:103], v[208:211], v[136:139], v[100:103]
    v_sub_f32 v218, v202, v18
    v_sub_f32 v219, v203, v18
    v_mfma_f32_16x16x32_bf16 v[104:107], v[208:211], v[152:155], v[104:107]
    v_exp_f32 v216, v216
    v_exp_f32 v217, v217
    v_mfma_f32_16x16x32_bf16 v[108:111], v[208:211], v[168:171], v[108:111]
    v_exp_f32 v218, v218
    v_exp_f32 v219, v219
    s_waitcnt vmcnt(0)
    s_waitcnt lgkmcnt(0)
    v_max3_u32 v17, v212, v213, v214
    v_mfma_f32_16x16x32_bf16 v[96:99], v[212:215], v[124:127], v[96:99]
    v_max3_u32 v16, v16, v17, v215
    v_mov_b32_dpp v216, v216 row_ror:8 row_mask:0xf bank_mask:0x3
    v_mov_b32_dpp v217, v217 row_ror:8 row_mask:0xf bank_mask:0x3
    v_mfma_f32_16x16x32_bf16 v[100:103], v[212:215], v[140:143], v[100:103]
    v_mov_b32_dpp v218, v218 row_ror:8 row_mask:0xf bank_mask:0x3
    v_mov_b32_dpp v219, v219 row_ror:8 row_mask:0xf bank_mask:0x3
    v_mfma_f32_16x16x32_bf16 v[104:107], v[212:215], v[156:159], v[104:107]
    v_add_f32 v18, v216, v217
    v_add_f32 v19, v218, v219
    v_mfma_f32_16x16x32_bf16 v[108:111], v[212:215], v[172:175], v[108:111]
    v_add_f32 v18, v18, v19
    v_mov_b32 v19, v18
    v_cmp_eq_u32 vcc, -1, v16
    s_cbranch_vccz Ld12
    s_sub_u32 s16, s16, 1
    s_cmp_gt_i32 s16, 0
    s_cbranch_scc1 Lp12
Ld12:
    v_permlane16_swap_b32 v18, v19
    v_mul_f32 v96, v96, v216
    v_add_f32 v16, v18, v19
    v_mul_f32 v100, v100, v216
    v_rcp_f32 v16, v16
    v_mul_f32 v104, v104, v216
    v_fmac_f32 v96, v97, v217
    v_fmac_f32 v100, v101, v217
    v_fmac_f32 v104, v105, v217
    v_mul_f32 v108, v108, v216
    v_fmac_f32 v96, v98, v218
    v_fmac_f32 v100, v102, v218
    v_fmac_f32 v104, v106, v218
    v_fmac_f32 v96, v99, v219
    v_fmac_f32 v100, v103, v219
    v_fmac_f32 v104, v107, v219
    v_fmac_f32 v108, v109, v217
    v_fmac_f32 v108, v110, v218
    v_fmac_f32 v108, v111, v219
    v_permlane16_swap_b32 v96, v100
    s_nop 0
    v_permlane16_swap_b32 v104, v108
    v_add_f32 v96, v96, v100
    v_add_f32 v104, v104, v108
    s_nop 1
    v_permlane32_swap_b32 v96, v104
    v_mul_f32 v96, v96, v16
    s_cmp_lg_u32 s8, 0
    s_nop 0
    v_mov_b32_dpp v97, v96 quad_perm:[1,0,3,2] row_mask:0xf bank_mask:0xf
    s_mov_b64 exec, s[14:15]
    v_cvt_pk_bf16_f32 v96, v96, v97
    buffer_store_dword v96, v6, s[60:63], s23 offen sc1
    s_mov_b64 exec, -1
    s_cbranch_scc1 Lfinal
    s_lshl_b32 s11, s96, 11
    s_lshl_b32 s10, s3, 9
    s_add_u32 s11, s11, s10
    s_lshl_b32 s10, s4, 17
    s_add_u32 s11, s11, s10
    s_add_u32 s11, s11, 0x00008400
    v_lshlrev_b32 v21, 7, v1
    s_mov_b64 exec, 15
    buffer_load_dword v231, v21, s[60:63], s11 offen sc1
    s_mov_b64 exec, -1
    s_cmp_lg_u32 s3, 0
    s_cbranch_scc1 Ltab
    s_lshl_b32 s11, s5, 15
    s_lshl_b32 s10, s6, 12
    s_add_u32 s11, s11, s10
    s_add_u32 s11, s11, 0x00100000
    s_lshl_b32 s12, s5, 10
    s_lshl_b32 s10, s6, 7
    s_add_u32 s12, s12, s10
    s_lshl_b32 s10, s4, 17
    s_add_u32 s12, s12, s10
    s_add_u32 s12, s12, 0x00014600
    s_mov_b32 s14, 0x00ff00ff
    s_mov_b32 s15, 0
    s_waitcnt vmcnt(0)
    s_mov_b32 s16, 0x00040000
Lp13:
    buffer_load_dwordx4 v[184:187], v2, s[60:63], s11 offen offset:0 sc1
    buffer_load_dwordx4 v[188:191], v2, s[60:63], s11 offen offset:1024 sc1
    buffer_load_dwordx4 v[192:195], v2, s[60:63], s11 offen offset:2048 sc1
    buffer_load_dwordx4 v[196:199], v2, s[60:63], s11 offen offset:3072 sc1
    s_waitcnt vmcnt(3)
    v_mfma_f32_16x16x32_bf16 v[200:203], v[176:179], v[184:187], 0
    v_max3_u32 v17, v184, v185, v186
    v_max_u32 v16, v17, v187
    s_waitcnt vmcnt(2)
    v_mfma_f32_16x16x32_bf16 v[200:203], v[176:179], v[188:191], v[200:203]
    v_max3_u32 v17, v188, v189, v190
    v_max3_u32 v16, v16, v17, v191
    s_waitcnt vmcnt(1)
    v_mfma_f32_16x16x32_bf16 v[200:203], v[176:179], v[192:195], v[200:203]
    v_max3_u32 v17, v192, v193, v194
    v_max3_u32 v16, v16, v17, v195
    s_waitcnt vmcnt(0)
    v_mfma_f32_16x16x32_bf16 v[200:203], v[176:179], v[196:199], v[200:203]
    v_max3_u32 v17, v196, v197, v198
    v_max3_u32 v16, v16, v17, v199
    v_cmp_eq_u32 vcc, -1, v16
    s_cbranch_vccz Ld13
    buffer_load_dwordx4 v[204:207], v2, s[60:63], s11 offen offset:0 sc1
    buffer_load_dwordx4 v[208:211], v2, s[60:63], s11 offen offset:1024 sc1
    buffer_load_dwordx4 v[212:215], v2, s[60:63], s11 offen offset:2048 sc1
    buffer_load_dwordx4 v[216:219], v2, s[60:63], s11 offen offset:3072 sc1
    s_sub_u32 s16, s16, 1
    s_waitcnt vmcnt(3)
    v_mfma_f32_16x16x32_bf16 v[200:203], v[176:179], v[204:207], 0
    v_max3_u32 v17, v204, v205, v206
    v_max_u32 v16, v17, v207
    s_waitcnt vmcnt(2)
    v_mfma_f32_16x16x32_bf16 v[200:203], v[176:179], v[208:211], v[200:203]
    v_max3_u32 v17, v208, v209, v210
    v_max3_u32 v16, v16, v17, v211
    s_waitcnt vmcnt(1)
    v_mfma_f32_16x16x32_bf16 v[200:203], v[176:179], v[212:215], v[200:203]
    v_max3_u32 v17, v212, v213, v214
    v_max3_u32 v16, v16, v17, v215
    s_waitcnt vmcnt(0)
    v_mfma_f32_16x16x32_bf16 v[200:203], v[176:179], v[216:219], v[200:203]
    v_max3_u32 v17, v216, v217, v218
    v_max3_u32 v16, v16, v17, v219
    v_cmp_eq_u32 vcc, -1, v16
    s_cbranch_vccz Ld13
    s_sub_u32 s16, s16, 1
    s_cmp_gt_i32 s16, 0
    s_cbranch_scc1 Lp13
Ld13:
    s_cmp_eq_u32 s9, 0
    s_nop 2
    v_add_f32_dpp v200, v200, v200 row_ror:8 row_mask:0xf bank_mask:0xf
    v_add_f32_dpp v201, v201, v201 row_ror:8 row_mask:0xf bank_mask:0xf
    v_add_f32_dpp v202, v202, v202 row_ror:8 row_mask:0xf bank_mask:0xf
    v_add_f32_dpp v203, v203, v203 row_ror:8 row_mask:0xf bank_mask:0xf
    s_mov_b64 exec, s[14:15]
    v_pk_add_f32 v[200:201], v[200:201], v[252:253]
    v_pk_add_f32 v[202:203], v[202:203], v[254:255]
    v_cvt_pk_bf16_f32 v200, v200, v201
    v_cvt_pk_bf16_f32 v201, v202, v203
    s_cbranch_scc1 Lw14
    buffer_store_dwordx2 v[200:201], v7, s[60:63], s12 offen
Lx14:
    s_mov_b64 exec, -1
Ltabdone:
    s_lshl_b32 s13, s3, 10
    s_lshl_b32 s10, s4, 17
    s_add_u32 s13, s13, s10
    s_add_u32 s13, s13, 0x00014600
    s_lshl_b32 s11, s3, 5
    v_xor_b32 v26, s11, v28
    ds_read_b64_tr_b16 v[96:97], v26 offset:12288
    ds_read_b64_tr_b16 v[98:99], v26 offset:12800
    ds_read_b64_tr_b16 v[100:101], v26 offset:16384
    ds_read_b64_tr_b16 v[102:103], v26 offset:16896
    ds_read_b64_tr_b16 v[104:105], v26 offset:20480
    ds_read_b64_tr_b16 v[106:107], v26 offset:20992
    ds_read_b64_tr_b16 v[108:109], v26 offset:24576
    ds_read_b64_tr_b16 v[110:111], v26 offset:25088
    s_mov_b32 s16, 0x00040000
    s_waitcnt vmcnt(0)
Lp15:
    buffer_load_dwordx4 v[248:251], v2, s[60:63], s13 offen sc1
    ds_read_b32 v18, v29 offset:20
    s_waitcnt vmcnt(0)
    s_waitcnt lgkmcnt(0)
    v_max3_u32 v16, v248, v249, v250
    v_max_u32 v16, v16, v251
    v_readfirstlane_b32 s11, v18
    v_cmp_eq_u32 vcc, -1, v16
    s_cbranch_vccz Ld15
    buffer_load_dwordx4 v[252:255], v2, s[60:63], s13 offen sc1
    s_sub_u32 s16, s16, 1
    s_waitcnt vmcnt(0)
    s_waitcnt lgkmcnt(0)
    v_max3_u32 v16, v252, v253, v254
    v_max_u32 v16, v16, v255
    v_readfirstlane_b32 s11, v18
    v_cmp_eq_u32 vcc, -1, v16
    v_mov_b32 v248, v252
    v_mov_b32 v249, v253
    v_mov_b32 v250, v254
    v_mov_b32 v251, v255
    s_cbranch_vccz Ld15
    s_sub_u32 s16, s16, 1
    s_cmp_gt_i32 s16, 0
    s_cbranch_scc1 Lp15
Ld15:
    s_cmp_lt_u32 s11, 3
    s_cbranch_scc1 Ltw
Ltwd:
Lmix:
    v_dot2_f32_bf16 v16, v248, v180, 0
    v_dot2_f32_bf16 v17, v248, v248, 0
    v_dot2_f32_bf16 v16, v249, v180, v16
    v_dot2_f32_bf16 v17, v249, v249, v17
    v_dot2_f32_bf16 v16, v250, v180, v16
    v_dot2_f32_bf16 v17, v250, v250, v17
    v_dot2_f32_bf16 v16, v251, v180, v16
    v_dot2_f32_bf16 v17, v251, v251, v17
    v_lshlrev_b32 v184, 16, v248
    v_and_b32 v185, 0xffff0000, v248
    v_lshlrev_b32 v186, 16, v249
    v_add_f32_dpp v16, v16, v16 row_ror:8 row_mask:0xf bank_mask:0xf
    v_add_f32_dpp v17, v17, v17 row_ror:8 row_mask:0xf bank_mask:0xf
    v_and_b32 v187, 0xffff0000, v249
    v_add_f32_dpp v16, v16, v16 row_ror:4 row_mask:0xf bank_mask:0xf
    v_add_f32_dpp v17, v17, v17 row_ror:4 row_mask:0xf bank_mask:0xf
    v_lshlrev_b32 v188, 16, v250
    v_add_f32_dpp v16, v16, v16 row_ror:2 row_mask:0xf bank_mask:0xf
    v_add_f32_dpp v17, v17, v17 row_ror:2 row_mask:0xf bank_mask:0xf
    v_and_b32 v189, 0xffff0000, v250
    v_add_f32_dpp v16, v16, v16 row_ror:1 row_mask:0xf bank_mask:0xf
    v_add_f32_dpp v17, v17, v17 row_ror:1 row_mask:0xf bank_mask:0xf
    v_lshlrev_b32 v190, 16, v251
    v_add_f32_dpp v16, v16, v16 row_bcast:15 row_mask:0xa bank_mask:0xf
    v_add_f32_dpp v17, v17, v17 row_bcast:15 row_mask:0xa bank_mask:0xf
    v_and_b32 v191, 0xffff0000, v251
    v_add_f32_dpp v16, v16, v16 row_bcast:31 row_mask:0xc bank_mask:0xf
    v_add_f32_dpp v17, v17, v17 row_bcast:31 row_mask:0xc bank_mask:0xf
    s_nop 0
    v_readlane_b32 s26, v16, 63
    v_readlane_b32 s27, v17, 63
    s_nop 0
    v_mul_f32 v16, s26, v15
    v_mul_f32 v17, s27, v15
    v_fma_f32 v17, -v16, v16, v17
    v_max_f32 v17, 0, v17
    v_add_f32 v18, 0x3727c5ac, v17
    v_rsq_f32 v18, v18
    v_mov_b32 v20, 0x6e006e00
    s_movk_i32 s15, 20480
    v_mul_f32 v17, v17, v18
    v_fmaak_f32 v17, v17, v18, 0x3727c5ac
    v_rsq_f32 v17, v17
    s_nop 0
    v_mul_f32 v18, v18, v17
    v_mul_f32 v19, v16, v18
    v_pk_fma_f32 v[200:201], v[184:185], v[18:19], v[18:19] op_sel:[0,0,1] op_sel_hi:[1,0,1] neg_lo:[0,0,1] neg_hi:[0,0,1]
    v_pk_fma_f32 v[202:203], v[186:187], v[18:19], v[18:19] op_sel:[0,0,1] op_sel_hi:[1,0,1] neg_lo:[0,0,1] neg_hi:[0,0,1]
    v_pk_fma_f32 v[204:205], v[188:189], v[18:19], v[18:19] op_sel:[0,0,1] op_sel_hi:[1,0,1] neg_lo:[0,0,1] neg_hi:[0,0,1]
    v_pk_fma_f32 v[206:207], v[190:191], v[18:19], v[18:19] op_sel:[0,0,1] op_sel_hi:[1,0,1] neg_lo:[0,0,1] neg_hi:[0,0,1]
    v_cvt_pk_bf16_f32 v192, v200, v201
    v_cvt_pk_bf16_f32 v193, v202, v203
    v_cvt_pk_bf16_f32 v194, v204, v205
    v_cvt_pk_bf16_f32 v195, v206, v207
    v_pk_lshlrev_b16 v196, 1, v192 op_sel_hi:[0,1]
    v_pk_lshrrev_b16 v200, 15, v192 op_sel_hi:[0,1]
    v_pk_lshlrev_b16 v197, 1, v193 op_sel_hi:[0,1]
    v_pk_lshrrev_b16 v201, 15, v193 op_sel_hi:[0,1]
    v_pk_lshlrev_b16 v198, 1, v194 op_sel_hi:[0,1]
    v_pk_lshrrev_b16 v202, 15, v194 op_sel_hi:[0,1]
    v_pk_lshlrev_b16 v199, 1, v195 op_sel_hi:[0,1]
    v_pk_lshrrev_b16 v203, 15, v195 op_sel_hi:[0,1]
    v_or_b32 v196, v196, v200
    v_or_b32 v197, v197, v201
    v_or_b32 v198, v198, v202
    v_or_b32 v199, v199, v203
    v_pk_sub_u16 v196, v196, v20
    v_pk_sub_u16 v197, v197, v20
    v_pk_sub_u16 v198, v198, v20
    v_pk_sub_u16 v199, v199, v20
    v_lshlrev_b32_sdwa v200, 2, v196 dst_sel:DWORD dst_unused:UNUSED_PAD src0_sel:DWORD src1_sel:WORD_0
    v_lshlrev_b32_sdwa v201, 2, v196 dst_sel:DWORD dst_unused:UNUSED_PAD src0_sel:DWORD src1_sel:WORD_1
    ds_read_b32 v208, v200 offset:61440
    ds_read_b32 v209, v201 offset:61440
    v_lshlrev_b32_sdwa v202, 2, v197 dst_sel:DWORD dst_unused:UNUSED_PAD src0_sel:DWORD src1_sel:WORD_0
    v_lshlrev_b32_sdwa v203, 2, v197 dst_sel:DWORD dst_unused:UNUSED_PAD src0_sel:DWORD src1_sel:WORD_1
    ds_read_b32 v210, v202 offset:61440
    ds_read_b32 v211, v203 offset:61440
    v_lshlrev_b32_sdwa v204, 2, v198 dst_sel:DWORD dst_unused:UNUSED_PAD src0_sel:DWORD src1_sel:WORD_0
    v_lshlrev_b32_sdwa v205, 2, v198 dst_sel:DWORD dst_unused:UNUSED_PAD src0_sel:DWORD src1_sel:WORD_1
    ds_read_b32 v212, v204 offset:61440
    ds_read_b32 v213, v205 offset:61440
    v_lshlrev_b32_sdwa v206, 2, v199 dst_sel:DWORD dst_unused:UNUSED_PAD src0_sel:DWORD src1_sel:WORD_0
    v_lshlrev_b32_sdwa v207, 2, v199 dst_sel:DWORD dst_unused:UNUSED_PAD src0_sel:DWORD src1_sel:WORD_1
    ds_read_b32 v214, v206 offset:61440
    ds_read_b32 v215, v207 offset:61440
    v_max3_u32 v16, v200, v201, v202
    v_max3_u32 v17, v203, v204, v205
    v_max3_u32 v16, v16, v206, v207
    v_max_u32 v16, v16, v17
    v_cmp_le_u32 s[28:29], s15, v16
    s_waitcnt lgkmcnt(5)
    v_max3_u32 v16, v208, v209, v210
    s_waitcnt lgkmcnt(2)
    v_max3_u32 v17, v211, v212, v213
    s_waitcnt lgkmcnt(0)
    v_max3_u32 v16, v16, v214, v215
    v_max_u32 v16, v16, v17
    v_cmp_eq_u32 vcc, -1, v16
Lslowdone:
    v_pk_add_f32 v[18:19], v[184:185], v[208:209]
    v_pk_add_f32 v[20:21], v[186:187], v[210:211]
    v_pk_add_f32 v[22:23], v[188:189], v[212:213]
    v_pk_add_f32 v[24:25], v[190:191], v[214:215]
    s_or_b64 vcc, vcc, s[28:29]
    s_cbranch_vccnz Lslow
    s_cmp_lg_u32 s8, 0
    v_cvt_pk_bf16_f32 v248, v18, v19
    v_cvt_pk_bf16_f32 v249, v20, v21
    v_cvt_pk_bf16_f32 v250, v22, v23
    v_cvt_pk_bf16_f32 v251, v24, v25
    s_cbranch_scc1 Lout
    s_mov_b32 s8, 1
    s_branch Llnq
.p2align 6
Lst_fin:
    s_setpc_b64 s[32:33]
Lfinal:
    s_cmp_ge_u32 s2, 4
    s_cbranch_scc1 Lepoch
    s_lshl_b32 s11, s2, 15
    s_lshl_b32 s10, s3, 13
    s_add_u32 s11, s11, s10
    s_add_u32 s11, s11, 0x00120000
    s_add_u32 s12, s11, 4096
    s_mul_i32 s10, s2, 1056
    s_lshl_b32 s13, s3, 8
    s_add_u32 s10, s10, s13
    s_add_u32 s10, s10, 98432
    v_add_u32 v20, s10, v7
    s_add_u32 s13, s13, 94208
    v_add_u32 v21, s13, v7
    ds_read_b64 v[232:233], v20
    ds_read_b64 v[234:235], v20 offset:128
    s_mov_b32 s14, 0x00ff00ff
    s_mov_b32 s15, 0
    s_cmp_lg_u32 s3, 3
    s_cbranch_scc1 Lfn3
    ds_read_b32 v16, v29 offset:48
    s_waitcnt lgkmcnt(0)
    v_readfirstlane_b32 s10, v16
    s_cmp_eq_u32 s10, 0
    s_cbranch_scc1 Lfn3
    s_mov_b32 s16, 0x00140000
    buffer_load_dwordx4 v[184:187], v2, s[60:63], s16 offen offset:0 sc1
    buffer_load_dwordx4 v[188:191], v2, s[60:63], s16 offen offset:1024 sc1
    buffer_load_dwordx4 v[192:195], v2, s[60:63], s16 offen offset:2048 sc1
    buffer_load_dwordx4 v[196:199], v2, s[60:63], s16 offen offset:3072 sc1
    v_add_u32 v22, 61440, v2
    s_waitcnt vmcnt(0)
    ds_write_b128 v22, v[184:187] offset:0
    ds_write_b128 v22, v[188:191] offset:1024
    ds_write_b128 v22, v[192:195] offset:2048
    ds_write_b128 v22, v[196:199] offset:3072
Lfn3:
    s_waitcnt lgkmcnt(0)
    s_waitcnt vmcnt(0)
    v_lshlrev_b32 v236, 16, v232
    v_and_b32 v237, 0xffff0000, v232
    v_lshlrev_b32 v238, 16, v233
    v_and_b32 v239, 0xffff0000, v233
    v_lshlrev_b32 v240, 16, v234
    v_and_b32 v241, 0xffff0000, v234
    v_lshlrev_b32 v242, 16, v235
    v_and_b32 v243, 0xffff0000, v235
    s_mov_b32 s16, 0x00040000
Lp16:
    buffer_load_dwordx4 v[32:35], v2, s[60:63], s11 offen offset:0 sc1
    buffer_load_dwordx4 v[36:39], v2, s[60:63], s11 offen offset:1024 sc1
    buffer_load_dwordx4 v[40:43], v2, s[60:63], s11 offen offset:2048 sc1
    buffer_load_dwordx4 v[44:47], v2, s[60:63], s11 offen offset:3072 sc1
    buffer_load_dwordx4 v[48:51], v2, s[60:63], s12 offen offset:0 sc1
    buffer_load_dwordx4 v[52:55], v2, s[60:63], s12 offen offset:1024 sc1
    buffer_load_dwordx4 v[56:59], v2, s[60:63], s12 offen offset:2048 sc1
    buffer_load_dwordx4 v[60:63], v2, s[60:63], s12 offen offset:3072 sc1
    s_waitcnt vmcnt(7)
    v_mfma_f32_16x16x32_bf16 v[216:219], v[176:179], v[32:35], 0
    v_max3_u32 v17, v32, v33, v34
    v_max_u32 v16, v17, v35
    s_waitcnt vmcnt(6)
    v_mfma_f32_16x16x32_bf16 v[216:219], v[176:179], v[36:39], v[216:219]
    v_max3_u32 v17, v36, v37, v38
    v_max3_u32 v16, v16, v17, v39
    s_waitcnt vmcnt(5)
    v_mfma_f32_16x16x32_bf16 v[216:219], v[176:179], v[40:43], v[216:219]
    v_max3_u32 v17, v40, v41, v42
    v_max3_u32 v16, v16, v17, v43
    s_waitcnt vmcnt(4)
    v_mfma_f32_16x16x32_bf16 v[216:219], v[176:179], v[44:47], v[216:219]
    v_max3_u32 v17, v44, v45, v46
    v_max3_u32 v16, v16, v17, v47
    s_waitcnt vmcnt(3)
    v_mfma_f32_16x16x32_bf16 v[220:223], v[176:179], v[48:51], 0
    v_max3_u32 v17, v48, v49, v50
    v_max3_u32 v16, v16, v17, v51
    s_waitcnt vmcnt(2)
    v_mfma_f32_16x16x32_bf16 v[220:223], v[176:179], v[52:55], v[220:223]
    v_max3_u32 v17, v52, v53, v54
    v_max3_u32 v16, v16, v17, v55
    s_waitcnt vmcnt(1)
    v_mfma_f32_16x16x32_bf16 v[220:223], v[176:179], v[56:59], v[220:223]
    v_max3_u32 v17, v56, v57, v58
    v_max3_u32 v16, v16, v17, v59
    s_waitcnt vmcnt(0)
    v_mfma_f32_16x16x32_bf16 v[220:223], v[176:179], v[60:63], v[220:223]
    v_max3_u32 v17, v60, v61, v62
    v_max3_u32 v16, v16, v17, v63
    v_cmp_eq_u32 vcc, -1, v16
    s_cbranch_vccz Ld16
    buffer_load_dwordx4 v[64:67], v2, s[60:63], s11 offen offset:0 sc1
    buffer_load_dwordx4 v[68:71], v2, s[60:63], s11 offen offset:1024 sc1
    buffer_load_dwordx4 v[72:75], v2, s[60:63], s11 offen offset:2048 sc1
    buffer_load_dwordx4 v[76:79], v2, s[60:63], s11 offen offset:3072 sc1
    buffer_load_dwordx4 v[80:83], v2, s[60:63], s12 offen offset:0 sc1
    buffer_load_dwordx4 v[84:87], v2, s[60:63], s12 offen offset:1024 sc1
    buffer_load_dwordx4 v[88:91], v2, s[60:63], s12 offen offset:2048 sc1
    buffer_load_dwordx4 v[92:95], v2, s[60:63], s12 offen offset:3072 sc1
    s_sub_u32 s16, s16, 1
    s_waitcnt vmcnt(7)
    v_mfma_f32_16x16x32_bf16 v[216:219], v[176:179], v[64:67], 0
    v_max3_u32 v17, v64, v65, v66
    v_max_u32 v16, v17, v67
    s_waitcnt vmcnt(6)
    v_mfma_f32_16x16x32_bf16 v[216:219], v[176:179], v[68:71], v[216:219]
    v_max3_u32 v17, v68, v69, v70
    v_max3_u32 v16, v16, v17, v71
    s_waitcnt vmcnt(5)
    v_mfma_f32_16x16x32_bf16 v[216:219], v[176:179], v[72:75], v[216:219]
    v_max3_u32 v17, v72, v73, v74
    v_max3_u32 v16, v16, v17, v75
    s_waitcnt vmcnt(4)
    v_mfma_f32_16x16x32_bf16 v[216:219], v[176:179], v[76:79], v[216:219]
    v_max3_u32 v17, v76, v77, v78
    v_max3_u32 v16, v16, v17, v79
    s_waitcnt vmcnt(3)
    v_mfma_f32_16x16x32_bf16 v[220:223], v[176:179], v[80:83], 0
    v_max3_u32 v17, v80, v81, v82
    v_max3_u32 v16, v16, v17, v83
    s_waitcnt vmcnt(2)
    v_mfma_f32_16x16x32_bf16 v[220:223], v[176:179], v[84:87], v[220:223]
    v_max3_u32 v17, v84, v85, v86
    v_max3_u32 v16, v16, v17, v87
    s_waitcnt vmcnt(1)
    v_mfma_f32_16x16x32_bf16 v[220:223], v[176:179], v[88:91], v[220:223]
    v_max3_u32 v17, v88, v89, v90
    v_max3_u32 v16, v16, v17, v91
    s_waitcnt vmcnt(0)
    v_mfma_f32_16x16x32_bf16 v[220:223], v[176:179], v[92:95], v[220:223]
    v_max3_u32 v17, v92, v93, v94
    v_max3_u32 v16, v16, v17, v95
    v_cmp_eq_u32 vcc, -1, v16
    s_cbranch_vccz Ld16
    s_sub_u32 s16, s16, 1
    s_cmp_gt_i32 s16, 0
    s_cbranch_scc1 Lp16
Ld16:
    s_nop 1
    v_add_f32_dpp v216, v216, v216 row_ror:8 row_mask:0xf bank_mask:0xf
    v_add_f32_dpp v217, v217, v217 row_ror:8 row_mask:0xf bank_mask:0xf
    v_add_f32_dpp v218, v218, v218 row_ror:8 row_mask:0xf bank_mask:0xf
    v_add_f32_dpp v219, v219, v219 row_ror:8 row_mask:0xf bank_mask:0xf
    v_add_f32_dpp v220, v220, v220 row_ror:8 row_mask:0xf bank_mask:0xf
    v_add_f32_dpp v221, v221, v221 row_ror:8 row_mask:0xf bank_mask:0xf
    v_add_f32_dpp v222, v222, v222 row_ror:8 row_mask:0xf bank_mask:0xf
    v_add_f32_dpp v223, v223, v223 row_ror:8 row_mask:0xf bank_mask:0xf
    s_mov_b64 exec, s[14:15]
    v_pk_add_f32 v[216:217], v[216:217], v[236:237]
    v_pk_add_f32 v[218:219], v[218:219], v[238:239]
    v_pk_add_f32 v[220:221], v[220:221], v[240:241]
    v_pk_add_f32 v[222:223], v[222:223], v[242:243]
    v_cvt_pk_bf16_f32 v216, v216, v217
    v_cvt_pk_bf16_f32 v217, v218, v219
    v_cvt_pk_bf16_f32 v218, v220, v221
    v_cvt_pk_bf16_f32 v219, v222, v223
    ds_write_b64 v21, v[216:217]
    ds_write_b64 v21, v[218:219] offset:128
    s_mov_b64 exec, -1
    s_cmp_lg_u32 s3, 0
    s_waitcnt lgkmcnt(0)
    s_barrier
    s_cbranch_scc1 Lfin_exit
    ds_read_b128 v[248:251], v8
    s_waitcnt lgkmcnt(0)
    s_branch Lmix
.p2align 6
Lst_out:
    s_setpc_b64 s[32:33]
Lout:
    s_lshl_b32 s10, s2, 10
    buffer_store_dwordx4 v[248:251], v2, s[68:71], s10 offen
Lfin_exit:
Lend:
    s_endpgm
Lepoch:
    s_lshl_b32 s10, s3, 8
    s_add_u32 s10, s10, s2
    s_cmp_lg_u32 s10, 4
    s_cbranch_scc1 Lfin_exit
    v_mov_b32 v16, s0
    v_mov_b32 v17, 0x00017f00
    s_mov_b64 exec, 1
    buffer_store_dword v16, v17, s[60:63], 0 offen sc1
    s_mov_b64 exec, -1
    s_branch Lfin_exit
.p2align 6
Lst_tab:
    s_setpc_b64 s[32:33]
Ltab:
    s_cmp_eq_u32 s3, 1
    s_cbranch_scc1 Lext
    s_sub_u32 s11, s3, 2
    s_mul_i32 s11, s11, 8192
    s_add_u32 s11, s11, 4096
    v_add_u32 v20, s11, v2
    v_add_u32 v20, 61440, v20
    s_add_u32 s11, s11, 0x00140000
    s_add_u32 s12, s11, 4096
    s_mov_b32 s16, 0x00040000
Lp17:
    buffer_load_dwordx4 v[184:187], v2, s[60:63], s11 offen offset:0 sc1
    buffer_load_dwordx4 v[188:191], v2, s[60:63], s11 offen offset:1024 sc1
    buffer_load_dwordx4 v[192:195], v2, s[60:63], s11 offen offset:2048 sc1
    buffer_load_dwordx4 v[196:199], v2, s[60:63], s11 offen offset:3072 sc1
    buffer_load_dwordx4 v[200:203], v2, s[60:63], s12 offen offset:0 sc1
    buffer_load_dwordx4 v[204:207], v2, s[60:63], s12 offen offset:1024 sc1
    buffer_load_dwordx4 v[208:211], v2, s[60:63], s12 offen offset:2048 sc1
    buffer_load_dwordx4 v[212:215], v2, s[60:63], s12 offen offset:3072 sc1
    s_waitcnt vmcnt(0)
    v_max3_u32 v16, v184, v185, v186
    v_max3_u32 v17, v187, v188, v189
    v_max3_u32 v16, v16, v190, v191
    v_max3_u32 v17, v17, v192, v193
    v_max3_u32 v16, v16, v194, v195
    v_max3_u32 v17, v17, v196, v197
    v_max3_u32 v16, v16, v198, v199
    v_max3_u32 v17, v17, v200, v201
    v_max3_u32 v16, v16, v202, v203
    v_max3_u32 v17, v17, v204, v205
    v_max3_u32 v16, v16, v206, v207
    v_max3_u32 v17, v17, v208, v209
    v_max3_u32 v16, v16, v210, v211
    v_max3_u32 v17, v17, v212, v213
    v_max3_u32 v16, v16, v214, v215
    v_max_u32 v16, v16, v17
    v_cmp_eq_u32 vcc, -1, v16
    s_cbranch_vccz Ld17
    s_sub_u32 s16, s16, 1
    s_sleep 16
    s_cbranch_scc0 Lp17
Ld17:
    ds_write_b128 v20, v[184:187] offset:0
    ds_write_b128 v20, v[188:191] offset:1024
    ds_write_b128 v20, v[192:195] offset:2048
    ds_write_b128 v20, v[196:199] offset:3072
    ds_write_b128 v20, v[200:203] offset:4096
    ds_write_b128 v20, v[204:207] offset:5120
    ds_write_b128 v20, v[208:211] offset:6144
    ds_write_b128 v20, v[212:215] offset:7168
    s_waitcnt lgkmcnt(0)
    v_mov_b32 v20, 1
    s_mov_b64 exec, 1
    ds_add_u32 v29, v20 offset:20
    s_mov_b64 exec, -1
    s_branch Ltabdone
Lext:
    s_mov_b32 s14, 0x00140000
    v_add_u32 v20, 61440, v2
    v_mov_b32 v184, -1
    v_mov_b32 v185, -1
    v_mov_b32 v186, -1
    v_mov_b32 v187, -1
    ds_write_b128 v20, v[184:187] offset:0
    ds_write_b128 v20, v[184:187] offset:1024
    ds_write_b128 v20, v[184:187] offset:2048
    ds_write_b128 v20, v[184:187] offset:3072
    ds_write_b32 v29, v184 offset:48
    s_waitcnt lgkmcnt(0)
    v_mov_b32 v21, 1
    s_mov_b64 exec, 1
    ds_add_u32 v29, v21 offset:20
    s_mov_b64 exec, -1
    s_lshl_b32 s13, s3, 10
    s_lshl_b32 s10, s4, 17
    s_add_u32 s13, s13, s10
    s_add_u32 s13, s13, 0x00014600
    s_waitcnt vmcnt(0)
    buffer_load_dwordx4 v[248:251], v2, s[60:63], s13 offen sc1
    s_waitcnt vmcnt(0)
    v_max3_u32 v16, v248, v249, v250
    v_max_u32 v16, v16, v251
    v_cmp_eq_u32 vcc, -1, v16
    s_cbranch_vccz Lexx
    s_mov_b32 s16, 1
Lexl:
    buffer_load_dwordx4 v[248:251], v2, s[60:63], s13 offen sc1
    buffer_load_dwordx4 v[216:219], v2, s[60:63], s14 offen offset:0 sc1
    buffer_load_dwordx4 v[220:223], v2, s[60:63], s14 offen offset:1024 sc1
    buffer_load_dwordx4 v[224:227], v2, s[60:63], s14 offen offset:2048 sc1
    buffer_load_dwordx4 v[228:231], v2, s[60:63], s14 offen offset:3072 sc1
    s_waitcnt vmcnt(4)
    v_max3_u32 v16, v248, v249, v250
    v_max_u32 v16, v16, v251
    v_cmp_eq_u32 vcc, -1, v16
    s_cbranch_vccz Lexx
    s_waitcnt vmcnt(0)
    ds_write_b128 v20, v[216:219] offset:0
    ds_write_b128 v20, v[220:223] offset:1024
    ds_write_b128 v20, v[224:227] offset:2048
    ds_write_b128 v20, v[228:231] offset:3072
    v_max3_u32 v16, v216, v217, v218
    v_max3_u32 v17, v219, v220, v221
    v_max3_u32 v16, v16, v222, v223
    v_max3_u32 v17, v17, v224, v225
    v_max3_u32 v16, v16, v226, v227
    v_max3_u32 v17, v17, v228, v229
    v_max3_u32 v16, v16, v230, v231
    v_max_u32 v16, v16, v17
    v_cmp_eq_u32 vcc, -1, v16
    s_cbranch_vccz Lexc
    s_sub_u32 s16, s16, 1
    s_cbranch_scc0 Lexl
    s_branch Ltabdone
Lexc:
    v_mov_b32 v16, 0
    ds_write_b32 v29, v16 offset:48
    s_branch Ltabdone
Lexx:
    s_lshl_b32 s11, s3, 5
    v_xor_b32 v26, s11, v28
    ds_read_b64_tr_b16 v[96:97], v26 offset:12288
    ds_read_b64_tr_b16 v[98:99], v26 offset:12800
    ds_read_b64_tr_b16 v[100:101], v26 offset:16384
    ds_read_b64_tr_b16 v[102:103], v26 offset:16896
    ds_read_b64_tr_b16 v[104:105], v26 offset:20480
    ds_read_b64_tr_b16 v[106:107], v26 offset:20992
    ds_read_b64_tr_b16 v[108:109], v26 offset:24576
    ds_read_b64_tr_b16 v[110:111], v26 offset:25088
    s_branch Ltw
Ltw:
    s_mov_b32 s12, 0x00100000
Ls18:
    ds_read_b32 v18, v29 offset:20
    s_waitcnt lgkmcnt(0)
    v_readfirstlane_b32 s11, v18
    s_cmp_ge_u32 s11, 3
    s_cbranch_scc1 Lt18
    s_sub_u32 s12, s12, 1
    s_cbranch_scc0 Ls18
Lt18:
    s_branch Ltwd
.p2align 6
Lst_mq:
    s_setpc_b64 s[32:33]
Lmqr:
    s_cmp_lg_u32 s37, 0
    s_cbranch_scc1 Lmqr2
    s_waitcnt vmcnt(0)
    s_mov_b32 s37, 1
    v_mov_b32 v184, v192
    v_mov_b32 v185, v193
    v_mov_b32 v186, v194
    v_mov_b32 v187, v195
    v_mov_b32 v188, v196
    v_mov_b32 v189, v197
    v_mov_b32 v190, v198
    v_mov_b32 v191, v199
    s_branch Lmq
Lmqr2:
    s_cmp_le_u32 s16, 0x0003fffa
    s_cselect_b32 s10, 0x00200000, 0
    s_xor_b32 s17, s17, s10
    buffer_load_dwordx4 v[184:187], v24, s[60:63], s17 offen sc1
    buffer_load_dwordx4 v[188:191], v24, s[60:63], s17 offen offset:16 sc1
    s_waitcnt vmcnt(0)
    s_sub_u32 s16, s16, 1
    s_cbranch_scc0 Lmq
    s_branch Lmqd
Lw6:
    buffer_store_dwordx2 v[188:189], v3, s[60:63], s18 offen sc1
    s_branch Lx6
Lw9:
    buffer_store_dword v192, v4, s[60:63], s20 offen sc1
    s_branch Lx9
Lw10:
    buffer_store_dword v21, v20, s[60:63], s22 offen sc1
    s_branch Lx10
Lar:
    s_sleep 4
    s_lshl_b32 s15, s3, 10
    s_add_u32 s15, s15, 0x00148000
    buffer_load_dwordx4 v[228:231], v2, s[60:63], s15 offen sc1
    s_waitcnt vmcnt(0)
    s_sub_u32 s14, s14, 1
    s_cbranch_scc0 Lap
    s_branch Lad
Lw14:
    buffer_store_dwordx2 v[200:201], v7, s[60:63], s12 offen sc1
    s_branch Lx14
Lslow:
    v_lshlrev_b32 v26, 3, v1
    s_load_dword s36, s[40:41], 0
    buffer_load_dwordx4 v[216:219], v2, s[72:75], 0 offen offset:0
    buffer_load_dwordx4 v[220:223], v2, s[72:75], 0 offen offset:1024
    buffer_load_dwordx4 v[224:227], v2, s[72:75], 0 offen offset:2048
    buffer_load_dwordx2 v[228:229], v26, s[72:75], 0 offen offset:3072
    buffer_load_dwordx4 v[232:235], v2, s[76:79], 0 offen offset:0
    buffer_load_dwordx4 v[236:239], v2, s[76:79], 0 offen offset:1024
    buffer_load_dwordx4 v[240:243], v2, s[76:79], 0 offen offset:2048
    buffer_load_dwordx2 v[244:245], v26, s[76:79], 0 offen offset:3072
    buffer_load_dwordx4 v[16:19], v2, s[80:83], 0 offen
    buffer_load_dwordx4 v[20:23], v2, s[80:83], 0 offen offset:1024
    buffer_load_dwordx2 v[24:25], v2, s[80:83], 0 offen offset:2048
    buffer_load_dwordx2 v[230:231], v2, s[80:83], 0 offen offset:2056
    buffer_load_dwordx2 v[246:247], v26, s[80:83], 0 offen offset:3072
    s_waitcnt vmcnt(0) lgkmcnt(0)
    s_lshl_b32 s36, s36, 16
    s_mov_b32 s14, 1
    v_cmp_le_u32 vcc, 20480, v200
    v_cmp_eq_u32 s[30:31], -1, v208
    s_or_b64 s[30:31], s[30:31], vcc
    v_lshlrev_b32 v199, 16, v192
Lse0:
    s_cmp_eq_u64 s[30:31], 0
    s_cbranch_scc1 Lsf0
    s_ff1_i32_b64 s10, s[30:31]
    s_nop 0
    v_readlane_b32 s28, v199, s10
    s_cmp_eq_u32 s28, s14
    s_cbranch_scc1 Lsg0
    s_mov_b32 s14, s28
    s_call_b64 s[32:33], Lgev
Lsg0:
    s_nop 1
    v_cmp_eq_u32 vcc, s28, v199
    v_mov_b32 v255, s37
    s_andn2_b64 s[30:31], s[30:31], vcc
    v_cndmask_b32 v208, v208, v255, vcc
    s_branch Lse0
Lsf0:
    v_cmp_le_u32 vcc, 20480, v201
    v_cmp_eq_u32 s[30:31], -1, v209
    s_or_b64 s[30:31], s[30:31], vcc
    v_and_b32 v199, 0xffff0000, v192
Lse1:
    s_cmp_eq_u64 s[30:31], 0
    s_cbranch_scc1 Lsf1
    s_ff1_i32_b64 s10, s[30:31]
    s_nop 0
    v_readlane_b32 s28, v199, s10
    s_cmp_eq_u32 s28, s14
    s_cbranch_scc1 Lsg1
    s_mov_b32 s14, s28
    s_call_b64 s[32:33], Lgev
Lsg1:
    s_nop 1
    v_cmp_eq_u32 vcc, s28, v199
    v_mov_b32 v255, s37
    s_andn2_b64 s[30:31], s[30:31], vcc
    v_cndmask_b32 v209, v209, v255, vcc
    s_branch Lse1
Lsf1:
    v_cmp_le_u32 vcc, 20480, v202
    v_cmp_eq_u32 s[30:31], -1, v210
    s_or_b64 s[30:31], s[30:31], vcc
    v_lshlrev_b32 v199, 16, v193
Lse2:
    s_cmp_eq_u64 s[30:31], 0
    s_cbranch_scc1 Lsf2
    s_ff1_i32_b64 s10, s[30:31]
    s_nop 0
    v_readlane_b32 s28, v199, s10
    s_cmp_eq_u32 s28, s14
    s_cbranch_scc1 Lsg2
    s_mov_b32 s14, s28
    s_call_b64 s[32:33], Lgev
Lsg2:
    s_nop 1
    v_cmp_eq_u32 vcc, s28, v199
    v_mov_b32 v255, s37
    s_andn2_b64 s[30:31], s[30:31], vcc
    v_cndmask_b32 v210, v210, v255, vcc
    s_branch Lse2
Lsf2:
    v_cmp_le_u32 vcc, 20480, v203
    v_cmp_eq_u32 s[30:31], -1, v211
    s_or_b64 s[30:31], s[30:31], vcc
    v_and_b32 v199, 0xffff0000, v193
Lse3:
    s_cmp_eq_u64 s[30:31], 0
    s_cbranch_scc1 Lsf3
    s_ff1_i32_b64 s10, s[30:31]
    s_nop 0
    v_readlane_b32 s28, v199, s10
    s_cmp_eq_u32 s28, s14
    s_cbranch_scc1 Lsg3
    s_mov_b32 s14, s28
    s_call_b64 s[32:33], Lgev
Lsg3:
    s_nop 1
    v_cmp_eq_u32 vcc, s28, v199
    v_mov_b32 v255, s37
    s_andn2_b64 s[30:31], s[30:31], vcc
    v_cndmask_b32 v211, v211, v255, vcc
    s_branch Lse3
Lsf3:
    v_cmp_le_u32 vcc, 20480, v204
    v_cmp_eq_u32 s[30:31], -1, v212
    s_or_b64 s[30:31], s[30:31], vcc
    v_lshlrev_b32 v199, 16, v194
Lse4:
    s_cmp_eq_u64 s[30:31], 0
    s_cbranch_scc1 Lsf4
    s_ff1_i32_b64 s10, s[30:31]
    s_nop 0
    v_readlane_b32 s28, v199, s10
    s_cmp_eq_u32 s28, s14
    s_cbranch_scc1 Lsg4
    s_mov_b32 s14, s28
    s_call_b64 s[32:33], Lgev
Lsg4:
    s_nop 1
    v_cmp_eq_u32 vcc, s28, v199
    v_mov_b32 v255, s37
    s_andn2_b64 s[30:31], s[30:31], vcc
    v_cndmask_b32 v212, v212, v255, vcc
    s_branch Lse4
Lsf4:
    v_cmp_le_u32 vcc, 20480, v205
    v_cmp_eq_u32 s[30:31], -1, v213
    s_or_b64 s[30:31], s[30:31], vcc
    v_and_b32 v199, 0xffff0000, v194
Lse5:
    s_cmp_eq_u64 s[30:31], 0
    s_cbranch_scc1 Lsf5
    s_ff1_i32_b64 s10, s[30:31]
    s_nop 0
    v_readlane_b32 s28, v199, s10
    s_cmp_eq_u32 s28, s14
    s_cbranch_scc1 Lsg5
    s_mov_b32 s14, s28
    s_call_b64 s[32:33], Lgev
Lsg5:
    s_nop 1
    v_cmp_eq_u32 vcc, s28, v199
    v_mov_b32 v255, s37
    s_andn2_b64 s[30:31], s[30:31], vcc
    v_cndmask_b32 v213, v213, v255, vcc
    s_branch Lse5
Lsf5:
    v_cmp_le_u32 vcc, 20480, v206
    v_cmp_eq_u32 s[30:31], -1, v214
    s_or_b64 s[30:31], s[30:31], vcc
    v_lshlrev_b32 v199, 16, v195
Lse6:
    s_cmp_eq_u64 s[30:31], 0
    s_cbranch_scc1 Lsf6
    s_ff1_i32_b64 s10, s[30:31]
    s_nop 0
    v_readlane_b32 s28, v199, s10
    s_cmp_eq_u32 s28, s14
    s_cbranch_scc1 Lsg6
    s_mov_b32 s14, s28
    s_call_b64 s[32:33], Lgev
Lsg6:
    s_nop 1
    v_cmp_eq_u32 vcc, s28, v199
    v_mov_b32 v255, s37
    s_andn2_b64 s[30:31], s[30:31], vcc
    v_cndmask_b32 v214, v214, v255, vcc
    s_branch Lse6
Lsf6:
    v_cmp_le_u32 vcc, 20480, v207
    v_cmp_eq_u32 s[30:31], -1, v215
    s_or_b64 s[30:31], s[30:31], vcc
    v_and_b32 v199, 0xffff0000, v195
Lse7:
    s_cmp_eq_u64 s[30:31], 0
    s_cbranch_scc1 Lsf7
    s_ff1_i32_b64 s10, s[30:31]
    s_nop 0
    v_readlane_b32 s28, v199, s10
    s_cmp_eq_u32 s28, s14
    s_cbranch_scc1 Lsg7
    s_mov_b32 s14, s28
    s_call_b64 s[32:33], Lgev
Lsg7:
    s_nop 1
    v_cmp_eq_u32 vcc, s28, v199
    v_mov_b32 v255, s37
    s_andn2_b64 s[30:31], s[30:31], vcc
    v_cndmask_b32 v215, v215, v255, vcc
    s_branch Lse7
Lsf7:
    v_mov_b32 v232, 0
    v_mov_b32 v233, 0
    v_mov_b32 v234, 0
    v_mov_b32 v235, 0
    v_mov_b32 v236, 0
    v_mov_b32 v237, 0
    v_mov_b32 v238, 0
    v_mov_b32 v239, 0
    v_mov_b32 v240, 0
    v_mov_b32 v241, 0
    v_mov_b32 v242, 0
    v_mov_b32 v243, 0
    v_mov_b32 v244, 0
    v_mov_b32 v245, 0
    v_mov_b32 v246, 0
    v_mov_b32 v247, 0
    s_mov_b64 vcc, 0
    s_mov_b64 s[28:29], 0
    s_branch Lslowdone
Lgev:
    v_mov_b32 v252, 0
    v_mov_b32 v197, 0xc0135761
    v_mov_b32 v198, 0xbdd2d3e8
    v_lshlrev_b32 v253, 16, v216
    v_lshlrev_b32 v254, 16, v232
    v_lshlrev_b32 v196, 16, v16
    v_fma_f32 v253, v253, s28, v254
    v_mul_f32 v254, v253, v253
    v_fma_f32 v254, v254, v198, v197
    v_mul_f32 v254, v254, v253
    v_exp_f32 v254, v254
    v_mul_f32 v196, v196, v253
    v_add_f32 v254, 1.0, v254
    v_rcp_f32 v254, v254
    s_nop 0
    v_fmac_f32 v252, v196, v254
    v_and_b32 v253, 0xffff0000, v216
    v_and_b32 v254, 0xffff0000, v232
    v_and_b32 v196, 0xffff0000, v16
    v_fma_f32 v253, v253, s28, v254
    v_mul_f32 v254, v253, v253
    v_fma_f32 v254, v254, v198, v197
    v_mul_f32 v254, v254, v253
    v_exp_f32 v254, v254
    v_mul_f32 v196, v196, v253
    v_add_f32 v254, 1.0, v254
    v_rcp_f32 v254, v254
    s_nop 0
    v_fmac_f32 v252, v196, v254
    v_lshlrev_b32 v253, 16, v217
    v_lshlrev_b32 v254, 16, v233
    v_lshlrev_b32 v196, 16, v17
    v_fma_f32 v253, v253, s28, v254
    v_mul_f32 v254, v253, v253
    v_fma_f32 v254, v254, v198, v197
    v_mul_f32 v254, v254, v253
    v_exp_f32 v254, v254
    v_mul_f32 v196, v196, v253
    v_add_f32 v254, 1.0, v254
    v_rcp_f32 v254, v254
    s_nop 0
    v_fmac_f32 v252, v196, v254
    v_and_b32 v253, 0xffff0000, v217
    v_and_b32 v254, 0xffff0000, v233
    v_and_b32 v196, 0xffff0000, v17
    v_fma_f32 v253, v253, s28, v254
    v_mul_f32 v254, v253, v253
    v_fma_f32 v254, v254, v198, v197
    v_mul_f32 v254, v254, v253
    v_exp_f32 v254, v254
    v_mul_f32 v196, v196, v253
    v_add_f32 v254, 1.0, v254
    v_rcp_f32 v254, v254
    s_nop 0
    v_fmac_f32 v252, v196, v254
    v_lshlrev_b32 v253, 16, v218
    v_lshlrev_b32 v254, 16, v234
    v_lshlrev_b32 v196, 16, v18
    v_fma_f32 v253, v253, s28, v254
    v_mul_f32 v254, v253, v253
    v_fma_f32 v254, v254, v198, v197
    v_mul_f32 v254, v254, v253
    v_exp_f32 v254, v254
    v_mul_f32 v196, v196, v253
    v_add_f32 v254, 1.0, v254
    v_rcp_f32 v254, v254
    s_nop 0
    v_fmac_f32 v252, v196, v254
    v_and_b32 v253, 0xffff0000, v218
    v_and_b32 v254, 0xffff0000, v234
    v_and_b32 v196, 0xffff0000, v18
    v_fma_f32 v253, v253, s28, v254
    v_mul_f32 v254, v253, v253
    v_fma_f32 v254, v254, v198, v197
    v_mul_f32 v254, v254, v253
    v_exp_f32 v254, v254
    v_mul_f32 v196, v196, v253
    v_add_f32 v254, 1.0, v254
    v_rcp_f32 v254, v254
    s_nop 0
    v_fmac_f32 v252, v196, v254
    v_lshlrev_b32 v253, 16, v219
    v_lshlrev_b32 v254, 16, v235
    v_lshlrev_b32 v196, 16, v19
    v_fma_f32 v253, v253, s28, v254
    v_mul_f32 v254, v253, v253
    v_fma_f32 v254, v254, v198, v197
    v_mul_f32 v254, v254, v253
    v_exp_f32 v254, v254
    v_mul_f32 v196, v196, v253
    v_add_f32 v254, 1.0, v254
    v_rcp_f32 v254, v254
    s_nop 0
    v_fmac_f32 v252, v196, v254
    v_and_b32 v253, 0xffff0000, v219
    v_and_b32 v254, 0xffff0000, v235
    v_and_b32 v196, 0xffff0000, v19
    v_fma_f32 v253, v253, s28, v254
    v_mul_f32 v254, v253, v253
    v_fma_f32 v254, v254, v198, v197
    v_mul_f32 v254, v254, v253
    v_exp_f32 v254, v254
    v_mul_f32 v196, v196, v253
    v_add_f32 v254, 1.0, v254
    v_rcp_f32 v254, v254
    s_nop 0
    v_fmac_f32 v252, v196, v254
    v_lshlrev_b32 v253, 16, v220
    v_lshlrev_b32 v254, 16, v236
    v_lshlrev_b32 v196, 16, v20
    v_fma_f32 v253, v253, s28, v254
    v_mul_f32 v254, v253, v253
    v_fma_f32 v254, v254, v198, v197
    v_mul_f32 v254, v254, v253
    v_exp_f32 v254, v254
    v_mul_f32 v196, v196, v253
    v_add_f32 v254, 1.0, v254
    v_rcp_f32 v254, v254
    s_nop 0
    v_fmac_f32 v252, v196, v254
    v_and_b32 v253, 0xffff0000, v220
    v_and_b32 v254, 0xffff0000, v236
    v_and_b32 v196, 0xffff0000, v20
    v_fma_f32 v253, v253, s28, v254
    v_mul_f32 v254, v253, v253
    v_fma_f32 v254, v254, v198, v197
    v_mul_f32 v254, v254, v253
    v_exp_f32 v254, v254
    v_mul_f32 v196, v196, v253
    v_add_f32 v254, 1.0, v254
    v_rcp_f32 v254, v254
    s_nop 0
    v_fmac_f32 v252, v196, v254
    v_lshlrev_b32 v253, 16, v221
    v_lshlrev_b32 v254, 16, v237
    v_lshlrev_b32 v196, 16, v21
    v_fma_f32 v253, v253, s28, v254
    v_mul_f32 v254, v253, v253
    v_fma_f32 v254, v254, v198, v197
    v_mul_f32 v254, v254, v253
    v_exp_f32 v254, v254
    v_mul_f32 v196, v196, v253
    v_add_f32 v254, 1.0, v254
    v_rcp_f32 v254, v254
    s_nop 0
    v_fmac_f32 v252, v196, v254
    v_and_b32 v253, 0xffff0000, v221
    v_and_b32 v254, 0xffff0000, v237
    v_and_b32 v196, 0xffff0000, v21
    v_fma_f32 v253, v253, s28, v254
    v_mul_f32 v254, v253, v253
    v_fma_f32 v254, v254, v198, v197
    v_mul_f32 v254, v254, v253
    v_exp_f32 v254, v254
    v_mul_f32 v196, v196, v253
    v_add_f32 v254, 1.0, v254
    v_rcp_f32 v254, v254
    s_nop 0
    v_fmac_f32 v252, v196, v254
    v_lshlrev_b32 v253, 16, v222
    v_lshlrev_b32 v254, 16, v238
    v_lshlrev_b32 v196, 16, v22
    v_fma_f32 v253, v253, s28, v254
    v_mul_f32 v254, v253, v253
    v_fma_f32 v254, v254, v198, v197
    v_mul_f32 v254, v254, v253
    v_exp_f32 v254, v254
    v_mul_f32 v196, v196, v253
    v_add_f32 v254, 1.0, v254
    v_rcp_f32 v254, v254
    s_nop 0
    v_fmac_f32 v252, v196, v254
    v_and_b32 v253, 0xffff0000, v222
    v_and_b32 v254, 0xffff0000, v238
    v_and_b32 v196, 0xffff0000, v22
    v_fma_f32 v253, v253, s28, v254
    v_mul_f32 v254, v253, v253
    v_fma_f32 v254, v254, v198, v197
    v_mul_f32 v254, v254, v253
    v_exp_f32 v254, v254
    v_mul_f32 v196, v196, v253
    v_add_f32 v254, 1.0, v254
    v_rcp_f32 v254, v254
    s_nop 0
    v_fmac_f32 v252, v196, v254
    v_lshlrev_b32 v253, 16, v223
    v_lshlrev_b32 v254, 16, v239
    v_lshlrev_b32 v196, 16, v23
    v_fma_f32 v253, v253, s28, v254
    v_mul_f32 v254, v253, v253
    v_fma_f32 v254, v254, v198, v197
    v_mul_f32 v254, v254, v253
    v_exp_f32 v254, v254
    v_mul_f32 v196, v196, v253
    v_add_f32 v254, 1.0, v254
    v_rcp_f32 v254, v254
    s_nop 0
    v_fmac_f32 v252, v196, v254
    v_and_b32 v253, 0xffff0000, v223
    v_and_b32 v254, 0xffff0000, v239
    v_and_b32 v196, 0xffff0000, v23
    v_fma_f32 v253, v253, s28, v254
    v_mul_f32 v254, v253, v253
    v_fma_f32 v254, v254, v198, v197
    v_mul_f32 v254, v254, v253
    v_exp_f32 v254, v254
    v_mul_f32 v196, v196, v253
    v_add_f32 v254, 1.0, v254
    v_rcp_f32 v254, v254
    s_nop 0
    v_fmac_f32 v252, v196, v254
    v_lshlrev_b32 v253, 16, v224
    v_lshlrev_b32 v254, 16, v240
    v_lshlrev_b32 v196, 16, v24
    v_fma_f32 v253, v253, s28, v254
    v_mul_f32 v254, v253, v253
    v_fma_f32 v254, v254, v198, v197
    v_mul_f32 v254, v254, v253
    v_exp_f32 v254, v254
    v_mul_f32 v196, v196, v253
    v_add_f32 v254, 1.0, v254
    v_rcp_f32 v254, v254
    s_nop 0
    v_fmac_f32 v252, v196, v254
    v_and_b32 v253, 0xffff0000, v224
    v_and_b32 v254, 0xffff0000, v240
    v_and_b32 v196, 0xffff0000, v24
    v_fma_f32 v253, v253, s28, v254
    v_mul_f32 v254, v253, v253
    v_fma_f32 v254, v254, v198, v197
    v_mul_f32 v254, v254, v253
    v_exp_f32 v254, v254
    v_mul_f32 v196, v196, v253
    v_add_f32 v254, 1.0, v254
    v_rcp_f32 v254, v254
    s_nop 0
    v_fmac_f32 v252, v196, v254
    v_lshlrev_b32 v253, 16, v225
    v_lshlrev_b32 v254, 16, v241
    v_lshlrev_b32 v196, 16, v25
    v_fma_f32 v253, v253, s28, v254
    v_mul_f32 v254, v253, v253
    v_fma_f32 v254, v254, v198, v197
    v_mul_f32 v254, v254, v253
    v_exp_f32 v254, v254
    v_mul_f32 v196, v196, v253
    v_add_f32 v254, 1.0, v254
    v_rcp_f32 v254, v254
    s_nop 0
    v_fmac_f32 v252, v196, v254
    v_and_b32 v253, 0xffff0000, v225
    v_and_b32 v254, 0xffff0000, v241
    v_and_b32 v196, 0xffff0000, v25
    v_fma_f32 v253, v253, s28, v254
    v_mul_f32 v254, v253, v253
    v_fma_f32 v254, v254, v198, v197
    v_mul_f32 v254, v254, v253
    v_exp_f32 v254, v254
    v_mul_f32 v196, v196, v253
    v_add_f32 v254, 1.0, v254
    v_rcp_f32 v254, v254
    s_nop 0
    v_fmac_f32 v252, v196, v254
    v_lshlrev_b32 v253, 16, v226
    v_lshlrev_b32 v254, 16, v242
    v_lshlrev_b32 v196, 16, v230
    v_fma_f32 v253, v253, s28, v254
    v_mul_f32 v254, v253, v253
    v_fma_f32 v254, v254, v198, v197
    v_mul_f32 v254, v254, v253
    v_exp_f32 v254, v254
    v_mul_f32 v196, v196, v253
    v_add_f32 v254, 1.0, v254
    v_rcp_f32 v254, v254
    s_nop 0
    v_fmac_f32 v252, v196, v254
    v_and_b32 v253, 0xffff0000, v226
    v_and_b32 v254, 0xffff0000, v242
    v_and_b32 v196, 0xffff0000, v230
    v_fma_f32 v253, v253, s28, v254
    v_mul_f32 v254, v253, v253
    v_fma_f32 v254, v254, v198, v197
    v_mul_f32 v254, v254, v253
    v_exp_f32 v254, v254
    v_mul_f32 v196, v196, v253
    v_add_f32 v254, 1.0, v254
    v_rcp_f32 v254, v254
    s_nop 0
    v_fmac_f32 v252, v196, v254
    v_lshlrev_b32 v253, 16, v227
    v_lshlrev_b32 v254, 16, v243
    v_lshlrev_b32 v196, 16, v231
    v_fma_f32 v253, v253, s28, v254
    v_mul_f32 v254, v253, v253
    v_fma_f32 v254, v254, v198, v197
    v_mul_f32 v254, v254, v253
    v_exp_f32 v254, v254
    v_mul_f32 v196, v196, v253
    v_add_f32 v254, 1.0, v254
    v_rcp_f32 v254, v254
    s_nop 0
    v_fmac_f32 v252, v196, v254
    v_and_b32 v253, 0xffff0000, v227
    v_and_b32 v254, 0xffff0000, v243
    v_and_b32 v196, 0xffff0000, v231
    v_fma_f32 v253, v253, s28, v254
    v_mul_f32 v254, v253, v253
    v_fma_f32 v254, v254, v198, v197
    v_mul_f32 v254, v254, v253
    v_exp_f32 v254, v254
    v_mul_f32 v196, v196, v253
    v_add_f32 v254, 1.0, v254
    v_rcp_f32 v254, v254
    s_nop 0
    v_fmac_f32 v252, v196, v254
    v_lshlrev_b32 v253, 16, v228
    v_lshlrev_b32 v254, 16, v244
    v_lshlrev_b32 v196, 16, v246
    v_fma_f32 v253, v253, s28, v254
    v_mul_f32 v254, v253, v253
    v_fma_f32 v254, v254, v198, v197
    v_mul_f32 v254, v254, v253
    v_exp_f32 v254, v254
    v_mul_f32 v196, v196, v253
    v_add_f32 v254, 1.0, v254
    v_rcp_f32 v254, v254
    s_nop 0
    v_fmac_f32 v252, v196, v254
    v_and_b32 v253, 0xffff0000, v228
    v_and_b32 v254, 0xffff0000, v244
    v_and_b32 v196, 0xffff0000, v246
    v_fma_f32 v253, v253, s28, v254
    v_mul_f32 v254, v253, v253
    v_fma_f32 v254, v254, v198, v197
    v_mul_f32 v254, v254, v253
    v_exp_f32 v254, v254
    v_mul_f32 v196, v196, v253
    v_add_f32 v254, 1.0, v254
    v_rcp_f32 v254, v254
    s_nop 0
    v_fmac_f32 v252, v196, v254
    v_lshlrev_b32 v253, 16, v229
    v_lshlrev_b32 v254, 16, v245
    v_lshlrev_b32 v196, 16, v247
    v_fma_f32 v253, v253, s28, v254
    v_mul_f32 v254, v253, v253
    v_fma_f32 v254, v254, v198, v197
    v_mul_f32 v254, v254, v253
    v_exp_f32 v254, v254
    v_mul_f32 v196, v196, v253
    v_add_f32 v254, 1.0, v254
    v_rcp_f32 v254, v254
    s_nop 0
    v_fmac_f32 v252, v196, v254
    v_and_b32 v253, 0xffff0000, v229
    v_and_b32 v254, 0xffff0000, v245
    v_and_b32 v196, 0xffff0000, v247
    v_fma_f32 v253, v253, s28, v254
    v_mul_f32 v254, v253, v253
    v_fma_f32 v254, v254, v198, v197
    v_mul_f32 v254, v254, v253
    v_exp_f32 v254, v254
    v_mul_f32 v196, v196, v253
    v_add_f32 v254, 1.0, v254
    v_rcp_f32 v254, v254
    s_nop 0
    v_fmac_f32 v252, v196, v254
    v_mov_b32 v253, v252
    s_nop 1
    v_add_f32_dpp v252, v252, v252 row_ror:8 row_mask:0xf bank_mask:0xf
    v_add_f32_dpp v253, v253, v253 row_ror:8 row_mask:0xf bank_mask:0xf
    s_nop 0
    v_add_f32_dpp v252, v252, v252 row_ror:4 row_mask:0xf bank_mask:0xf
    v_add_f32_dpp v253, v253, v253 row_ror:4 row_mask:0xf bank_mask:0xf
    s_nop 0
    v_add_f32_dpp v252, v252, v252 row_ror:2 row_mask:0xf bank_mask:0xf
    v_add_f32_dpp v253, v253, v253 row_ror:2 row_mask:0xf bank_mask:0xf
    s_nop 0
    v_add_f32_dpp v252, v252, v252 row_ror:1 row_mask:0xf bank_mask:0xf
    v_add_f32_dpp v253, v253, v253 row_ror:1 row_mask:0xf bank_mask:0xf
    s_nop 0
    v_add_f32_dpp v252, v252, v252 row_bcast:15 row_mask:0xa bank_mask:0xf
    v_add_f32_dpp v253, v253, v253 row_bcast:15 row_mask:0xa bank_mask:0xf
    s_nop 0
    v_add_f32_dpp v252, v252, v252 row_bcast:31 row_mask:0xc bank_mask:0xf
    v_add_f32_dpp v253, v253, v253 row_bcast:31 row_mask:0xc bank_mask:0xf
    s_nop 0
    v_readlane_b32 s37, v252, 63
    v_readlane_b32 s11, v253, 63
    s_nop 1
    v_mov_b32 v252, s37
    v_cvt_pk_bf16_f32 v252, v252, v252
    v_and_b32 v252, 0xffff0000, v252
    v_add_f32 v252, s36, v252
    v_cvt_pk_bf16_f32 v252, v252, v252
    v_and_b32 v252, 0xffff0000, v252
    s_nop 0
    v_readfirstlane_b32 s37, v252
    s_nop 3
    s_setpc_b64 s[32:33]
    s_endpgm
.p2align 8
.fill 512, 4, 0xBF800000
.section .rodata,"a"
.p2align 6
.amdhsa_kernel interleave_layers__sliding_block_cached__mixer_token_mlp__decode_kernel
  .amdhsa_next_free_vgpr 256
  .amdhsa_next_free_sgpr 102
  .amdhsa_accum_offset 256
  .amdhsa_group_segment_fixed_size 0
  .amdhsa_kernarg_size 104
  .amdhsa_user_sgpr_count 2
  .amdhsa_user_sgpr_kernarg_segment_ptr 1
  .amdhsa_system_sgpr_workgroup_id_x 1
.end_amdhsa_kernel
```
